```python
import torch

def _softmax(x, axis=-1):
    return torch.softmax(x, dim=axis)
def _gelu(x):
    return torch.nn.functional.gelu(x, approximate="tanh")
def _silu(x):
    return torch.nn.functional.silu(x)
def _sigmoid(x):
    return torch.sigmoid(x)
def _layernorm(x, axis=-1, eps=1e-5):
    m = x.mean(dim=axis, keepdim=True)
    v = x.var(dim=axis, keepdim=True, unbiased=False)
    return (x - m) / torch.sqrt(v + eps)
def _scatter_add(tgt, idx, src, axis=0):
    return tgt.clone().index_add_(axis, idx, src)
def _segment_sum(src, seg, n):
    out = torch.zeros((n,) + src.shape[1:], dtype=src.dtype)
    return out.index_add_(0, seg, src)
def _pad(x, pw):
    flat = tuple(v for pair in reversed(pw) for v in pair)
    return torch.nn.functional.pad(x, flat)

kernel_name = 'sequential_preLN__ssm_conv_h3__glu_gated_glu__prompt'

def setup_inputs():

    _w = (lambda a: (lambda t: t.to(torch.bfloat16) if t.is_floating_point() else t)(torch.as_tensor(a)))
    def _A_setup():
        B, S, D = 1, 2048, 448
        ks = 4
        return {
            "q": _w((lambda *s: torch.randn(*s, dtype=torch.bfloat16) * 0.05)(B, S, D)),
            "k": _w((lambda *s: torch.randn(*s, dtype=torch.bfloat16) * 0.4)(B, S, D)),
            "v": _w((lambda *s: torch.randn(*s, dtype=torch.bfloat16) * 0.4)(B, S, D)),
            "shift_k": _w((lambda *s: torch.randn(*s, dtype=torch.bfloat16) * 0.4)(D, ks) * 0.5),
            "ssm_k": _w((lambda *s: torch.randn(*s, dtype=torch.bfloat16) * 0.4)(D, S) * (1.0 / S ** 0.5)),
            "ssm_D": _w((lambda *s: torch.randn(*s, dtype=torch.bfloat16) * 0.4)(D)),
        }
    _A_in = _A_setup()

    def _B_setup():
        B, S, D, F = 1, 2048, 448, 1792
        return {
            "x": _w((lambda *s: torch.randn(*s, dtype=torch.bfloat16) * 0.05)(B, S, D)),
            "w_gate": _w((lambda *s: torch.randn(*s, dtype=torch.bfloat16) * 0.05)(D, F)),
            "w_up": _w((lambda *s: torch.randn(*s, dtype=torch.bfloat16) * 0.05)(D, F)),
            "w_down": _w((lambda *s: torch.randn(*s, dtype=torch.bfloat16) * 0.05)(F, D)),
        }
    _B_in = _B_setup()

    return {
        "A_q": _A_in["q"],
        "A_k": _A_in["k"],
        "A_v": _A_in["v"],
        "A_shift_k": _A_in["shift_k"],
        "A_ssm_k": _A_in["ssm_k"],
        "A_ssm_D": _A_in["ssm_D"],
        "B_x": _B_in["x"],
        "B_w_gate": _B_in["w_gate"],
        "B_w_up": _B_in["w_up"],
        "B_w_down": _B_in["w_down"],
    }

def reference(A_q, A_k, A_v, A_shift_k, A_ssm_k, A_ssm_D, B_x, B_w_gate, B_w_up, B_w_down):
    def _A_ref(q, k, v, shift_k, ssm_k, ssm_D):
        B, S, D = q.shape
        ks = shift_k.shape[-1]
        k_pad = _pad(k, ((0, 0), (ks - 1, 0), (0, 0)))
        k_shift = torch.zeros_like(k)
        for t in range(ks):
            k_shift = k_shift + k_pad[:, t:t + S, :] * shift_k[:, ks - 1 - t][None, None, :]
        kv = k_shift * v
        L = 2 * S
        kv_pad = _pad(kv, ((0, 0), (0, S), (0, 0)))
        kf_pad = _pad(ssm_k, ((0, 0), (0, S)))
        kv_f = (lambda x, axes=(-2,-1): torch.fft.rfft2(x.float(), dim=axes))(kv_pad[:, None, :, :], axes=(1, 2))
        kf_f = (lambda x, axes=(-2,-1): torch.fft.rfft2(x.float(), dim=axes))(kf_pad[:, None, :], axes=(1, 2))
        kf_f = (lambda x, *d: x.permute(*d))(kf_f, 1, 2, 0)
        y_f = kv_f * kf_f[None, :, :, :]
        y = (lambda x, s, axes=(-2,-1): torch.fft.irfft2(x, s=s, dim=axes).to(torch.bfloat16))(y_f, (1, L), axes=(1, 2))[:, 0, :S, :]
        y = y + kv * ssm_D[None, None, :]
        return q * y

    def _B_ref(x, w_gate, w_up, w_down):
        g = torch.einsum("bsd,df->bsf", x, w_gate)
        u = torch.einsum("bsd,df->bsf", x, w_up)
        h = _sigmoid(g) * u
        return torch.einsum("bsf,fd->bsd", h, w_down)

    x = A_q
    h = x + _A_ref(_layernorm(x, axis=-1), A_k, A_v, A_shift_k, A_ssm_k, A_ssm_D)
    h2 = h + _B_ref(_layernorm(h, axis=-1), B_w_gate, B_w_up, B_w_down)
    return h2
```

```asm
; @launch grid=(256,1,1) block=(256,1,1) lds=163840
.amdgcn_target "amdgcn-amd-amdhsa--gfx950"
.text
.globl sequential_preLN__ssm_conv_h3__glu_gated_glu__prompt_kernel
.p2align 8
.type sequential_preLN__ssm_conv_h3__glu_gated_glu__prompt_kernel,@function
sequential_preLN__ssm_conv_h3__glu_gated_glu__prompt_kernel:
  s_load_dwordx8 s[52:59], s[0:1], 0
  s_getpc_b64 s[48:49]
L_pc:
  v_and_b32 v4, 7, v0
  s_lshr_b32 s76, s2, 3
  v_lshlrev_b32 v4, 7, v4
  s_lshl_b32 s76, s76, 10
  v_add_u32 v4, s76, v4
  v_min_u32 v4, L_codeend-L_pc-4, v4
  global_load_dword v253, v4, s[48:49]
  v_lshrrev_b32 v3, 6, v0
  s_load_dwordx4 s[60:63], s[0:1], 32
  s_load_dwordx4 s[64:67], s[0:1], 56
  s_load_dwordx4 s[68:71], s[0:1], 72
  s_load_dwordx4 s[72:75], s[0:1], 88
  v_and_b32 v1, 63, v0
  v_readfirstlane_b32 s3, v3
  s_cmp_ge_u32 s2, 256
  s_cbranch_scc1 L_exit
  s_cmp_ge_u32 s2, 224
  s_cbranch_scc1 L_helper
  s_mul_i32 s86, s2, 293
  s_lshr_b32 s86, s86, 11
  s_mul_i32 s76, s86, 7
  s_sub_u32 s85, s2, s76
  s_mul_i32 s84, s86, 57344
  s_lshl_b32 s76, s85, 7
  s_add_u32 s84, s84, s76
  v_lshrrev_b32 v7, 4, v1
  v_and_b32 v7, 1, v7
  v_lshlrev_b32 v7, 1, v7
  v_and_b32 v4, 7, v1
  v_xor_b32 v4, v4, v7
  v_lshlrev_b32 v4, 4, v4
  v_lshrrev_b32 v7, 3, v1
  v_mul_u32_u24 v7, 896, v7
  v_add_u32 v4, v4, v7
  s_and_b32 s76, s3, 1
  s_lshl_b32 s76, s76, 6
  v_xor_b32 v5, s76, v4
  v_xor_b32 v6, 64, v4
  s_cmp_eq_u32 s86, 0
  s_cselect_b32 s77, 0x80000000, 0
  v_add_u32 v6, s77, v6
  s_sub_u32 s78, s84, 7168
  s_cmp_eq_u32 s86, 0
  s_cselect_b32 s78, 0, s78
  s_mul_i32 s79, s3, 7168
  s_add_u32 s79, s79, s84
  s_add_u32 s80, s79, 28672
  s_lshl_b32 s81, s3, 10
  s_waitcnt lgkmcnt(0)
  s_cmp_eq_u32 s2, 0
  s_cbranch_scc0 L_cz_1
  s_cmp_eq_u32 s3, 3
  s_cbranch_scc0 L_cz_1
  s_mov_b32 s44, s72
  s_mov_b32 s45, s73
  s_mov_b32 s46, 256
  s_mov_b32 s47, 0x20000
  s_mov_b32 s4, s74
  s_mov_b32 s5, s75
  s_mov_b32 s6, 16777216
  s_mov_b32 s7, 0x20000
  v_mov_b32 v20, 0
  v_lshlrev_b32 v19, 8, v1
  v_add_u32 v19, 14745600, v19
  buffer_store_dword v20, v19, s[4:7], 0 offen sc1
  v_add_u32 v19, 16384, v19
  s_mov_b64 exec, 0xffff
  buffer_store_dword v20, v19, s[4:7], 0 offen sc1
  s_mov_b64 exec, -1
L_cz_1:
  s_mov_b32 s12, s54
  s_mov_b32 s13, s55
  s_mov_b32 s14, 1835008
  s_mov_b32 s15, 0x20000
  s_mov_b32 s16, s56
  s_mov_b32 s17, s57
  s_mov_b32 s18, 1835008
  s_mov_b32 s19, 0x20000
  s_mov_b32 s8, s52
  s_mov_b32 s9, s53
  s_mov_b32 s10, 1835008
  s_mov_b32 s11, 0x20000
  s_mov_b32 m0, 114688
  s_nop 0
  buffer_load_dwordx4 v6, s[12:15], s78 offen lds
  s_add_u32 m0, s81, 115712
  s_nop 0
  buffer_load_dwordx4 v5, s[12:15], s79 offen lds
  s_add_u32 m0, s81, 119808
  s_nop 0
  buffer_load_dwordx4 v5, s[12:15], s80 offen lds
  s_add_u32 m0, s81, 123904
  s_nop 0
  buffer_load_dwordx4 v5, s[16:19], s79 offen lds
  s_add_u32 m0, s81, 128000
  s_nop 0
  buffer_load_dwordx4 v5, s[16:19], s80 offen lds
  s_add_u32 m0, s81, 132096
  s_nop 0
  buffer_load_dwordx4 v5, s[8:11], s79 offen lds
  s_add_u32 m0, s81, 136192
  s_nop 0
  buffer_load_dwordx4 v5, s[8:11], s80 offen lds
  s_mov_b32 s24, s58
  s_mov_b32 s25, s59
  s_mov_b32 s26, 3584
  s_mov_b32 s27, 0x20000
  s_mov_b32 s20, s60
  s_mov_b32 s21, s61
  s_mov_b32 s22, 1835008
  s_mov_b32 s23, 0x20000
  s_lshl_b32 s76, s85, 6
  s_lshl_b32 s77, s3, 4
  s_add_u32 s76, s76, s77
  v_and_b32 v8, 15, v1
  v_add_u32 v8, s76, v8
  v_lshlrev_b32 v7, 3, v8
  buffer_load_dwordx2 v[10:11], v7, s[24:27], 0 offen
  s_lshr_b32 s99, s3, 1
  s_and_b32 s98, s3, 1
  v_lshlrev_b32 v9, 4, v1
  s_lshl_b32 s76, s2, 1
  s_add_u32 s76, s76, s99
  s_lshl_b32 s76, s76, 12
  s_lshl_b32 s77, s98, 11
  s_add_u32 s76, s76, s77
  s_mul_i32 s78, s99, 8320
  s_add_u32 s78, s78, s77
  s_add_u32 m0, s78, 140320
  s_nop 0
  buffer_load_dwordx4 v9, s[20:23], s76 offen offset:0 lds
  buffer_load_dwordx4 v9, s[20:23], s76 offen offset:1024 lds
  s_cmp_eq_u32 s2, 0
  s_cbranch_scc0 L_cg_2
  s_cmp_eq_u32 s3, 3
  s_cbranch_scc0 L_cg_2
  s_mov_b32 s44, s72
  s_mov_b32 s45, s73
  s_mov_b32 s46, 256
  s_mov_b32 s47, 0x20000
  v_mov_b32 v20, 0
  s_waitcnt vmcnt(10)
  v_mov_b32 v19, 1
  s_mov_b64 exec, 1
  buffer_store_dword v19, v20, s[44:47], 0 offen offset:0 sc1
  s_mov_b64 exec, -1
L_cg_2:
  s_mov_b32 s28, s64
  s_mov_b32 s29, s65
  s_mov_b32 s30, 1605632
  s_mov_b32 s31, 0x20000
  s_mov_b32 s32, s66
  s_mov_b32 s33, s67
  s_mov_b32 s34, 1605632
  s_mov_b32 s35, 0x20000
  s_mov_b32 s36, s68
  s_mov_b32 s37, s69
  s_mov_b32 s38, 1605632
  s_mov_b32 s39, 0x20000
  s_sub_u32 s32, s32, 1024
  s_subb_u32 s33, s33, 0
  s_add_u32 s34, s34, 1024
  s_mov_b32 s40, s70
  s_mov_b32 s41, s71
  s_mov_b32 s42, 1835008
  s_mov_b32 s43, 0x20000
  s_mov_b32 s44, s72
  s_mov_b32 s45, s73
  s_mov_b32 s46, 256
  s_mov_b32 s47, 0x20000
  s_mov_b32 s4, s74
  s_mov_b32 s5, s75
  s_mov_b32 s6, 16777216
  s_mov_b32 s7, 0x20000
  s_and_b32 s76, s2, 7
  s_lshr_b32 s77, s2, 3
  s_mul_i32 s78, s77, 37
  s_lshr_b32 s78, s78, 8
  s_mul_i32 s79, s78, 7
  s_sub_u32 s79, s77, s79
  s_lshr_b32 s80, s76, 1
  s_lshl_b32 s80, s80, 2
  s_add_u32 s87, s80, s78
  s_and_b32 s80, s76, 1
  s_mul_i32 s80, s80, 7
  s_add_u32 s88, s80, s79
  s_lshl_b32 s80, s76, 2
  s_add_u32 s80, s80, s78
  s_lshr_b32 s89, s80, 1
  s_and_b32 s90, s80, 1
  s_mov_b32 s91, s79
  s_lshl_b32 s79, s2, 2
  s_load_dword s50, s[62:63], s79
  v_lshrrev_b32 v15, 4, v1
  v_bfe_u32 v16, v1, 2, 2
  v_lshrrev_b32 v7, 1, v16
  v_and_b32 v13, 1, v15
  v_lshl_or_b32 v7, v13, 1, v7
  v_xor_b32 v7, s3, v7
  v_lshlrev_b32 v7, 5, v7
  v_lshl_add_u32 v13, v15, 3, v16
  v_lshl_add_u32 v13, v13, 7, v7
  v_and_b32 v7, 3, v1
  v_lshl_add_u32 v13, v7, 3, v13
  v_add_u32 v13, 114688, v13
  v_xor_b32 v14, 64, v13
  s_lshl_b32 s76, s86, 7
  v_lshlrev_b32 v18, 12, v8
  v_lshlrev_b32 v7, 4, v15
  s_sub_u32 s77, 4016, s76
  v_add_u32 v17, s77, v18
  v_sub_u32 v17, v17, v7
  s_add_u32 s77, s76, 2097152
  v_add3_u32 v18, v18, v7, s77
  s_waitcnt vmcnt(2)
  s_waitcnt lgkmcnt(0)
  s_lshl_b32 s76, s50, 16
  s_and_b32 s77, s50, 0xffff0000
  s_cmp_eq_u32 s99, 0
  s_cselect_b32 s50, s76, s77
  s_barrier
  ds_read_b64_tr_b16 v[24:25], v14 offset:512
  ds_read_b64_tr_b16 v[26:27], v13 offset:1024
  ds_read_b64_tr_b16 v[28:29], v13 offset:1536
  ds_read_b64_tr_b16 v[40:41], v13 offset:9216
  ds_read_b64_tr_b16 v[42:43], v13 offset:9728
  ds_read_b64_tr_b16 v[34:35], v14 offset:4608
  ds_read_b64_tr_b16 v[36:37], v13 offset:5120
  ds_read_b64_tr_b16 v[38:39], v13 offset:5632
  ds_read_b64_tr_b16 v[44:45], v13 offset:13312
  ds_read_b64_tr_b16 v[46:47], v13 offset:13824
  ds_read_b64_tr_b16 v[48:49], v13 offset:17408
  ds_read_b64_tr_b16 v[50:51], v13 offset:17920
  ds_read_b64_tr_b16 v[52:53], v13 offset:21504
  ds_read_b64_tr_b16 v[54:55], v13 offset:22016
  v_alignbit_b32 v21, v10, v10, 16
  v_alignbit_b32 v22, v11, v11, 16
  s_waitcnt lgkmcnt(9)
  v_alignbit_b32 v56, v25, v24, 16
  v_alignbit_b32 v57, v26, v25, 16
  v_alignbit_b32 v58, v27, v26, 16
  v_alignbit_b32 v59, v28, v27, 16
  v_alignbit_b32 v60, v29, v28, 16
  v_dot2_f32_bf16 v64, v56, v22, 0
  v_dot2_f32_bf16 v65, v25, v22, 0
  v_dot2_f32_bf16 v66, v57, v22, 0
  v_dot2_f32_bf16 v67, v26, v22, 0
  v_dot2_f32_bf16 v68, v58, v22, 0
  v_dot2_f32_bf16 v69, v27, v22, 0
  v_dot2_f32_bf16 v70, v59, v22, 0
  v_dot2_f32_bf16 v71, v28, v22, 0
  v_dot2_f32_bf16 v64, v57, v21, v64
  v_dot2_f32_bf16 v65, v26, v21, v65
  v_dot2_f32_bf16 v66, v58, v21, v66
  v_dot2_f32_bf16 v67, v27, v21, v67
  v_dot2_f32_bf16 v68, v59, v21, v68
  v_dot2_f32_bf16 v69, v28, v21, v69
  v_dot2_f32_bf16 v70, v60, v21, v70
  v_dot2_f32_bf16 v71, v29, v21, v71
  v_lshlrev_b32 v72, 16, v40
  v_and_b32 v73, 0xffff0000, v40
  v_lshlrev_b32 v74, 16, v41
  v_and_b32 v75, 0xffff0000, v41
  v_lshlrev_b32 v76, 16, v42
  v_and_b32 v77, 0xffff0000, v42
  v_lshlrev_b32 v78, 16, v43
  v_and_b32 v79, 0xffff0000, v43
  v_mul_f32 v64, v64, v72
  v_mul_f32 v65, v65, v73
  v_mul_f32 v66, v66, v74
  v_mul_f32 v67, v67, v75
  v_mul_f32 v68, v68, v76
  v_mul_f32 v69, v69, v77
  v_mul_f32 v70, v70, v78
  v_mul_f32 v71, v71, v79
  v_cvt_pk_bf16_f32 v80, v71, v70
  v_cvt_pk_bf16_f32 v81, v69, v68
  v_cvt_pk_bf16_f32 v82, v67, v66
  v_cvt_pk_bf16_f32 v83, v65, v64
  buffer_store_dwordx4 v[80:83], v17, s[4:7], 0 offen offset:64 sc1
  s_waitcnt lgkmcnt(4)
  v_alignbit_b32 v56, v35, v34, 16
  v_alignbit_b32 v57, v36, v35, 16
  v_alignbit_b32 v58, v37, v36, 16
  v_alignbit_b32 v59, v38, v37, 16
  v_alignbit_b32 v60, v39, v38, 16
  v_dot2_f32_bf16 v64, v56, v22, 0
  v_dot2_f32_bf16 v65, v35, v22, 0
  v_dot2_f32_bf16 v66, v57, v22, 0
  v_dot2_f32_bf16 v67, v36, v22, 0
  v_dot2_f32_bf16 v68, v58, v22, 0
  v_dot2_f32_bf16 v69, v37, v22, 0
  v_dot2_f32_bf16 v70, v59, v22, 0
  v_dot2_f32_bf16 v71, v38, v22, 0
  v_dot2_f32_bf16 v64, v57, v21, v64
  v_dot2_f32_bf16 v65, v36, v21, v65
  v_dot2_f32_bf16 v66, v58, v21, v66
  v_dot2_f32_bf16 v67, v37, v21, v67
  v_dot2_f32_bf16 v68, v59, v21, v68
  v_dot2_f32_bf16 v69, v38, v21, v69
  v_dot2_f32_bf16 v70, v60, v21, v70
  v_dot2_f32_bf16 v71, v39, v21, v71
  v_lshlrev_b32 v72, 16, v44
  v_and_b32 v73, 0xffff0000, v44
  v_lshlrev_b32 v74, 16, v45
  v_and_b32 v75, 0xffff0000, v45
  v_lshlrev_b32 v76, 16, v46
  v_and_b32 v77, 0xffff0000, v46
  v_lshlrev_b32 v78, 16, v47
  v_and_b32 v79, 0xffff0000, v47
  v_mul_f32 v64, v64, v72
  v_mul_f32 v65, v65, v73
  v_mul_f32 v66, v66, v74
  v_mul_f32 v67, v67, v75
  v_mul_f32 v68, v68, v76
  v_mul_f32 v69, v69, v77
  v_mul_f32 v70, v70, v78
  v_mul_f32 v71, v71, v79
  v_cvt_pk_bf16_f32 v84, v71, v70
  v_cvt_pk_bf16_f32 v85, v69, v68
  v_cvt_pk_bf16_f32 v86, v67, v66
  v_cvt_pk_bf16_f32 v87, v65, v64
  buffer_store_dwordx4 v[84:87], v17, s[4:7], 0 offen offset:0 sc1
  s_waitcnt lgkmcnt(0)
  buffer_store_dwordx4 v[48:51], v18, s[4:7], 0 offen offset:0 sc1
  buffer_store_dwordx4 v[52:55], v18, s[4:7], 0 offen offset:64 sc1
  v_mov_b32 v58, 0
  buffer_load_dword v23, v58, s[44:47], 0 offen offset:0 sc1
  v_lshrrev_b32 v7, 2, v1
  v_mul_u32_u24 v7, 3584, v7
  v_and_b32 v248, 3, v1
  v_xor_b32 v249, 2, v248
  v_lshl_add_u32 v248, v248, 4, v7
  v_lshl_add_u32 v249, v249, 4, v7
  v_add_u32 v250, 55296, v248
  v_add_u32 v251, 55296, v249
  v_bfe_u32 v7, v1, 4, 1
  v_lshrrev_b32 v4, 5, v1
  v_lshlrev_b32 v4, 3, v4
  v_bfe_u32 v246, v1, 2, 2
  v_add_u32 v4, v4, v246
  v_lshlrev_b32 v4, 6, v4
  v_and_b32 v246, 3, v1
  v_lshl_add_u32 v4, v246, 3, v4
  v_mul_u32_u24 v7, 1056, v7
  s_mul_i32 s76, s3, 28672
  v_add3_u32 v246, v4, v7, s76
  v_xor_b32 v247, 32, v246
  v_mov_b32 v19, 0
  s_mul_i32 s78, s99, 8320
  s_add_u32 s78, s78, 140288
  v_lshl_add_u32 v22, v1, 2, s78
  v_mov_b32 v20, s78
  v_add_u32 v20, 4128, v20
  v_cmp_gt_u32 vcc, 8, v1
  s_nop 1
  v_cndmask_b32 v20, v20, v22, vcc
  s_mov_b64 exec, 0x1ff
  ds_write_b32 v20, v19
  s_mov_b64 exec, -1
  s_lshl_b32 s77, s98, 11
  s_add_u32 s77, s77, s78
  s_add_u32 s77, s77, 32
  v_lshl_add_u32 v21, v1, 4, s77
  s_waitcnt vmcnt(5)
  s_waitcnt lgkmcnt(0)
  s_barrier
  ds_read_b128 v[100:103], v21 offset:0
  ds_read_b32 v104, v21 offset:16
  ds_read_b128 v[106:109], v21 offset:1024
  ds_read_b32 v110, v21 offset:1040
  ds_read2_b32 v[112:113], v22 offset0:0 offset1:1
  s_mul_i32 s76, s99, 4608
  s_lshl_b32 s77, s98, 8
  s_add_u32 s76, s76, s77
  s_add_u32 s76, s76, 118784
  v_lshl_add_u32 v20, v1, 2, s76
  ds_write_b32 v20, v19
  s_waitcnt lgkmcnt(0)
  v_alignbit_b32 v116, v101, v100, 16
  v_alignbit_b32 v117, v102, v101, 16
  v_alignbit_b32 v118, v103, v102, 16
  v_alignbit_b32 v119, v104, v103, 16
  v_alignbit_b32 v120, v107, v106, 16
  v_alignbit_b32 v121, v108, v107, 16
  v_alignbit_b32 v122, v109, v108, 16
  v_alignbit_b32 v123, v110, v109, 16
  v_alignbit_b32 v124, v113, v112, 16
  ds_write_b128 v21, v[116:119] offset:4160
  ds_write_b128 v21, v[120:123] offset:5184
  s_mov_b64 exec, 0xff
  ds_write_b32 v22, v124 offset:4160
  s_mov_b64 exec, -1
  s_waitcnt lgkmcnt(0)
  s_barrier
  v_and_b32 v7, 15, v1
  v_and_b32 v4, 1, v7
  v_add_u32 v7, v7, v4
  v_lshrrev_b32 v240, 4, v1
  v_lshl_add_u32 v7, v240, 3, v7
  v_lshlrev_b32 v7, 1, v7
  v_xor_b32 v4, 1, v4
  v_mul_u32_u24 v4, 4160, v4
  s_mul_i32 s76, s99, 8320
  s_lshl_b32 s77, s98, 8
  s_add_u32 s76, s76, s77
  s_add_u32 s76, s76, 140288
  v_add3_u32 v240, v7, v4, s76
  v_add_u32 v241, 1024, v240
  v_add_u32 v242, 2048, v240
  v_add_u32 v243, 3072, v240
  s_cmp_eq_u32 s3, 0
  s_cbranch_scc1 L_p0_3
  s_lshl_b32 s56, s88, 8
  s_lshl_b32 s75, s3, 6
  s_add_u32 s56, s56, s75
  s_mul_i32 s75, s3, 28672
  s_and_b32 s57, s87, 3
  s_lshl_b32 s57, s57, 1
  s_mul_i32 s51, s57, 114688
  s_add_u32 s51, s51, s56
  s_lshl_b32 s74, s57, 12
  s_add_u32 m0, s74, s75
  s_nop 0
  buffer_load_dwordx4 v248, s[28:31], s51 offen offset:0 lds
  ds_read2_b32 a[112:113], v240 offset0:0 offset1:1
  ds_read2_b32 a[114:115], v240 offset0:2 offset1:3
  ds_read2_b32 a[116:117], v240 offset0:128 offset1:129
  ds_read2_b32 a[118:119], v240 offset0:130 offset1:131
  ds_read2_b32 a[120:121], v241 offset0:0 offset1:1
  ds_read2_b32 a[122:123], v241 offset0:2 offset1:3
  ds_read2_b32 a[124:125], v241 offset0:128 offset1:129
  ds_read2_b32 a[126:127], v241 offset0:130 offset1:131
  buffer_load_dwordx4 v249, s[32:35], s51 offen offset:1024 lds
  ds_read2_b32 a[128:129], v242 offset0:0 offset1:1
  ds_read2_b32 a[130:131], v242 offset0:2 offset1:3
  ds_read2_b32 a[132:133], v242 offset0:128 offset1:129
  ds_read2_b32 a[134:135], v242 offset0:130 offset1:131
  ds_read2_b32 a[136:137], v243 offset0:0 offset1:1
  ds_read2_b32 a[138:139], v243 offset0:2 offset1:3
  ds_read2_b32 a[140:141], v243 offset0:128 offset1:129
  ds_read2_b32 a[142:143], v243 offset0:130 offset1:131
  buffer_load_dwordx4 v250, s[28:31], s51 offen offset:2048 lds
  ds_read2_b32 a[144:145], v240 offset0:16 offset1:17
  ds_read2_b32 a[146:147], v240 offset0:18 offset1:19
  ds_read2_b32 a[148:149], v240 offset0:144 offset1:145
  ds_read2_b32 a[150:151], v240 offset0:146 offset1:147
  ds_read2_b32 a[152:153], v241 offset0:16 offset1:17
  ds_read2_b32 a[154:155], v241 offset0:18 offset1:19
  ds_read2_b32 a[156:157], v241 offset0:144 offset1:145
  ds_read2_b32 a[158:159], v241 offset0:146 offset1:147
  buffer_load_dwordx4 v251, s[32:35], s51 offen offset:3072 lds
  ds_read2_b32 a[160:161], v242 offset0:16 offset1:17
  ds_read2_b32 a[162:163], v242 offset0:18 offset1:19
  ds_read2_b32 a[164:165], v242 offset0:144 offset1:145
  ds_read2_b32 a[166:167], v242 offset0:146 offset1:147
  ds_read2_b32 a[168:169], v243 offset0:16 offset1:17
  ds_read2_b32 a[170:171], v243 offset0:18 offset1:19
  ds_read2_b32 a[172:173], v243 offset0:144 offset1:145
  ds_read2_b32 a[174:175], v243 offset0:146 offset1:147
  s_add_u32 s57, s57, 1
  s_cmp_eq_u32 s57, 7
  s_cselect_b32 s57, 0, s57
  s_mul_i32 s51, s57, 114688
  s_add_u32 s51, s51, s56
  s_lshl_b32 s74, s57, 12
  s_add_u32 m0, s74, s75
  s_nop 0
  buffer_load_dwordx4 v248, s[28:31], s51 offen offset:0 lds
  ds_read2_b32 a[176:177], v240 offset0:32 offset1:33
  ds_read2_b32 a[178:179], v240 offset0:34 offset1:35
  ds_read2_b32 a[180:181], v240 offset0:160 offset1:161
  ds_read2_b32 a[182:183], v240 offset0:162 offset1:163
  ds_read2_b32 a[184:185], v241 offset0:32 offset1:33
  ds_read2_b32 a[186:187], v241 offset0:34 offset1:35
  ds_read2_b32 a[188:189], v241 offset0:160 offset1:161
  ds_read2_b32 a[190:191], v241 offset0:162 offset1:163
  buffer_load_dwordx4 v249, s[32:35], s51 offen offset:1024 lds
  ds_read2_b32 a[192:193], v242 offset0:32 offset1:33
  ds_read2_b32 a[194:195], v242 offset0:34 offset1:35
  ds_read2_b32 a[196:197], v242 offset0:160 offset1:161
  ds_read2_b32 a[198:199], v242 offset0:162 offset1:163
  ds_read2_b32 a[200:201], v243 offset0:32 offset1:33
  ds_read2_b32 a[202:203], v243 offset0:34 offset1:35
  ds_read2_b32 a[204:205], v243 offset0:160 offset1:161
  ds_read2_b32 a[206:207], v243 offset0:162 offset1:163
  buffer_load_dwordx4 v250, s[28:31], s51 offen offset:2048 lds
  ds_read2_b32 a[208:209], v240 offset0:48 offset1:49
  ds_read2_b32 a[210:211], v240 offset0:50 offset1:51
  ds_read2_b32 a[212:213], v240 offset0:176 offset1:177
  ds_read2_b32 a[214:215], v240 offset0:178 offset1:179
  ds_read2_b32 a[216:217], v241 offset0:48 offset1:49
  ds_read2_b32 a[218:219], v241 offset0:50 offset1:51
  ds_read2_b32 a[220:221], v241 offset0:176 offset1:177
  ds_read2_b32 a[222:223], v241 offset0:178 offset1:179
  buffer_load_dwordx4 v251, s[32:35], s51 offen offset:3072 lds
  ds_read2_b32 a[224:225], v242 offset0:48 offset1:49
  ds_read2_b32 a[226:227], v242 offset0:50 offset1:51
  ds_read2_b32 a[228:229], v242 offset0:176 offset1:177
  ds_read2_b32 a[230:231], v242 offset0:178 offset1:179
  ds_read2_b32 a[232:233], v243 offset0:48 offset1:49
  ds_read2_b32 a[234:235], v243 offset0:50 offset1:51
  ds_read2_b32 a[236:237], v243 offset0:176 offset1:177
  ds_read2_b32 a[238:239], v243 offset0:178 offset1:179
  s_waitcnt vmcnt(8)
  s_branch L_pj_4
L_p0_3:
  ds_read2_b32 a[112:113], v240 offset0:0 offset1:1
  ds_read2_b32 a[114:115], v240 offset0:2 offset1:3
  ds_read2_b32 a[116:117], v240 offset0:128 offset1:129
  ds_read2_b32 a[118:119], v240 offset0:130 offset1:131
  ds_read2_b32 a[120:121], v241 offset0:0 offset1:1
  ds_read2_b32 a[122:123], v241 offset0:2 offset1:3
  ds_read2_b32 a[124:125], v241 offset0:128 offset1:129
  ds_read2_b32 a[126:127], v241 offset0:130 offset1:131
  ds_read2_b32 a[128:129], v242 offset0:0 offset1:1
  ds_read2_b32 a[130:131], v242 offset0:2 offset1:3
  ds_read2_b32 a[132:133], v242 offset0:128 offset1:129
  ds_read2_b32 a[134:135], v242 offset0:130 offset1:131
  ds_read2_b32 a[136:137], v243 offset0:0 offset1:1
  ds_read2_b32 a[138:139], v243 offset0:2 offset1:3
  ds_read2_b32 a[140:141], v243 offset0:128 offset1:129
  ds_read2_b32 a[142:143], v243 offset0:130 offset1:131
  ds_read2_b32 a[144:145], v240 offset0:16 offset1:17
  ds_read2_b32 a[146:147], v240 offset0:18 offset1:19
  ds_read2_b32 a[148:149], v240 offset0:144 offset1:145
  ds_read2_b32 a[150:151], v240 offset0:146 offset1:147
  ds_read2_b32 a[152:153], v241 offset0:16 offset1:17
  ds_read2_b32 a[154:155], v241 offset0:18 offset1:19
  ds_read2_b32 a[156:157], v241 offset0:144 offset1:145
  ds_read2_b32 a[158:159], v241 offset0:146 offset1:147
  ds_read2_b32 a[160:161], v242 offset0:16 offset1:17
  ds_read2_b32 a[162:163], v242 offset0:18 offset1:19
  ds_read2_b32 a[164:165], v242 offset0:144 offset1:145
  ds_read2_b32 a[166:167], v242 offset0:146 offset1:147
  ds_read2_b32 a[168:169], v243 offset0:16 offset1:17
  ds_read2_b32 a[170:171], v243 offset0:18 offset1:19
  ds_read2_b32 a[172:173], v243 offset0:144 offset1:145
  ds_read2_b32 a[174:175], v243 offset0:146 offset1:147
  ds_read2_b32 a[176:177], v240 offset0:32 offset1:33
  ds_read2_b32 a[178:179], v240 offset0:34 offset1:35
  ds_read2_b32 a[180:181], v240 offset0:160 offset1:161
  ds_read2_b32 a[182:183], v240 offset0:162 offset1:163
  ds_read2_b32 a[184:185], v241 offset0:32 offset1:33
  ds_read2_b32 a[186:187], v241 offset0:34 offset1:35
  ds_read2_b32 a[188:189], v241 offset0:160 offset1:161
  ds_read2_b32 a[190:191], v241 offset0:162 offset1:163
  ds_read2_b32 a[192:193], v242 offset0:32 offset1:33
  ds_read2_b32 a[194:195], v242 offset0:34 offset1:35
  ds_read2_b32 a[196:197], v242 offset0:160 offset1:161
  ds_read2_b32 a[198:199], v242 offset0:162 offset1:163
  ds_read2_b32 a[200:201], v243 offset0:32 offset1:33
  ds_read2_b32 a[202:203], v243 offset0:34 offset1:35
  ds_read2_b32 a[204:205], v243 offset0:160 offset1:161
  ds_read2_b32 a[206:207], v243 offset0:162 offset1:163
  ds_read2_b32 a[208:209], v240 offset0:48 offset1:49
  ds_read2_b32 a[210:211], v240 offset0:50 offset1:51
  ds_read2_b32 a[212:213], v240 offset0:176 offset1:177
  ds_read2_b32 a[214:215], v240 offset0:178 offset1:179
  ds_read2_b32 a[216:217], v241 offset0:48 offset1:49
  ds_read2_b32 a[218:219], v241 offset0:50 offset1:51
  ds_read2_b32 a[220:221], v241 offset0:176 offset1:177
  ds_read2_b32 a[222:223], v241 offset0:178 offset1:179
  ds_read2_b32 a[224:225], v242 offset0:48 offset1:49
  ds_read2_b32 a[226:227], v242 offset0:50 offset1:51
  ds_read2_b32 a[228:229], v242 offset0:176 offset1:177
  ds_read2_b32 a[230:231], v242 offset0:178 offset1:179
  ds_read2_b32 a[232:233], v243 offset0:48 offset1:49
  ds_read2_b32 a[234:235], v243 offset0:50 offset1:51
  ds_read2_b32 a[236:237], v243 offset0:176 offset1:177
  ds_read2_b32 a[238:239], v243 offset0:178 offset1:179
  s_waitcnt vmcnt(0)
L_pj_4:
  s_mov_b32 s92, 40000
L_go_5:
  v_cmp_eq_u32 vcc, 0, v23
  s_nop 4
  s_cbranch_vccz L_god_6
  buffer_load_dword v23, v58, s[44:47], 0 offen offset:0 sc1
  s_waitcnt vmcnt(0)
  s_sub_u32 s92, s92, 1
  s_cmp_lg_u32 s92, 0
  s_cbranch_scc1 L_go_5
L_god_6:
  s_barrier
  s_lshl_b32 s76, s85, 11
  s_add_u32 s76, s76, 14745600
  v_lshl_add_u32 v5, v1, 8, s76
  v_mov_b32 v6, 1
  s_cmp_eq_u32 s3, 0
  s_cbranch_scc0 L_sig_7
  s_mov_b64 exec, 255
  buffer_atomic_add v6, v5, s[4:7], 0 offen sc1
  s_mov_b64 exec, -1
L_sig_7:
  v_lshlrev_b32 v9, 4, v1
  s_lshl_b32 s76, s2, 1
  s_add_u32 s76, s76, s99
  s_lshl_b32 s76, s76, 12
  v_and_b32 v7, 15, v1
  v_lshrrev_b32 v4, 4, v1
  v_lshlrev_b32 v4, 2, v4
  v_lshl_add_u32 v5, v7, 4, v4
  s_lshl_b32 s77, s98, 10
  v_add_u32 v5, s77, v5
  s_add_u32 s78, s76, 2097152
  v_lshl_add_u32 v6, v5, 1, s78
  v_lshlrev_b32 v8, 2, v5
  s_mov_b32 s80, 14680064
  s_mov_b32 s81, 14688256
  v_and_b32 v7, 15, v1
  v_lshrrev_b32 v4, 4, v1
  v_lshlrev_b32 v4, 4, v4
  v_lshlrev_b32 v7, 5, v7
  v_sub_u32 v10, v4, v7
  s_mul_i32 s76, s99, 4608
  s_lshl_b32 s77, s98, 8
  s_add_u32 s77, s77, s76
  s_add_u32 s77, s77, 115168
  v_add_u32 v10, s77, v10
  s_add_u32 s77, s76, 117240
  v_lshlrev_b32 v7, 1, v5
  v_sub_u32 v11, s77, v7
  s_lshl_b32 s76, s3, 12
  s_add_u32 s77, s76, 140288
  v_add_u32 v12, s77, v9
  s_xor_b32 s76, s76, 0x1000
  s_add_u32 s77, s76, 140288
  v_add_u32 v13, s77, v9
  v_lshrrev_b32 v15, 4, v1
  v_and_b32 v7, 15, v1
  v_lshrrev_b32 v4, 1, v7
  v_and_b32 v14, 1, v15
  v_lshl_add_u32 v4, v14, 3, v4
  v_mul_u32_u24 v14, 28672, v4
  v_and_b32 v7, 1, v7
  v_lshl_add_u32 v14, v7, 5, v14
  v_lshrrev_b32 v15, 1, v15
  v_lshl_add_u32 v14, v15, 4, v14
  s_lshl_b32 s76, s2, 1
  s_add_u32 s76, s76, s99
  s_lshl_b32 s76, s76, 6
  s_mul_i32 s77, s98, 917504
  s_add_u32 s76, s76, s77
  s_add_u32 s82, s76, 4194304
  s_add_u32 s83, s82, 458752
  v_lshl_add_u32 v16, v5, 2, 0
  v_add_u32 v16, 123904, v16
  s_cmp_eq_u32 s3, 0
  s_cbranch_scc1 L_w0_8
  s_mul_i32 s76, s2, 7168
  s_sub_u32 s77, s3, 1
  s_mul_i32 s77, s77, 2432
  s_add_u32 s76, s76, s77
  v_lshl_add_u32 v59, v1, 7, s76
  s_mov_b64 exec, 0x7ffff
  buffer_load_dword v252, v59, s[28:31], 0 offen
  buffer_load_dword v252, v59, s[32:35], 0 offen offset:1024
  buffer_load_dword v252, v59, s[36:39], 0 offen
  s_mov_b64 exec, -1
  s_add_u32 s57, s57, 1
  s_cmp_eq_u32 s57, 7
  s_cselect_b32 s57, 0, s57
  s_mul_i32 s51, s57, 114688
  s_add_u32 s51, s51, s56
  s_lshl_b32 s74, s57, 12
  s_add_u32 m0, s74, s75
  s_nop 0
  buffer_load_dwordx4 v248, s[28:31], s51 offen offset:0 lds
  buffer_load_dwordx4 v249, s[32:35], s51 offen offset:1024 lds
  buffer_load_dwordx4 v250, s[28:31], s51 offen offset:2048 lds
  buffer_load_dwordx4 v251, s[32:35], s51 offen offset:3072 lds
  s_add_u32 s57, s57, 1
  s_cmp_eq_u32 s57, 7
  s_cselect_b32 s57, 0, s57
  s_mul_i32 s51, s57, 114688
  s_add_u32 s51, s51, s56
  s_lshl_b32 s74, s57, 12
  s_add_u32 m0, s74, s75
  s_nop 0
  buffer_load_dwordx4 v248, s[28:31], s51 offen offset:0 lds
  buffer_load_dwordx4 v249, s[32:35], s51 offen offset:1024 lds
  buffer_load_dwordx4 v250, s[28:31], s51 offen offset:2048 lds
  buffer_load_dwordx4 v251, s[32:35], s51 offen offset:3072 lds
  s_add_u32 s57, s57, 1
  s_cmp_eq_u32 s57, 7
  s_cselect_b32 s57, 0, s57
  s_mul_i32 s51, s57, 114688
  s_add_u32 s51, s51, s56
  s_lshl_b32 s74, s57, 12
  s_add_u32 m0, s74, s75
  s_nop 0
  buffer_load_dwordx4 v248, s[28:31], s51 offen offset:0 lds
  buffer_load_dwordx4 v249, s[32:35], s51 offen offset:1024 lds
  buffer_load_dwordx4 v250, s[28:31], s51 offen offset:2048 lds
  buffer_load_dwordx4 v251, s[32:35], s51 offen offset:3072 lds
  s_add_u32 s57, s57, 1
  s_cmp_eq_u32 s57, 7
  s_cselect_b32 s57, 0, s57
  s_mul_i32 s51, s57, 114688
  s_add_u32 s51, s51, s56
  s_lshl_b32 s74, s57, 12
  s_add_u32 m0, s74, s75
  s_nop 0
  buffer_load_dwordx4 v248, s[28:31], s51 offen offset:0 lds
  buffer_load_dwordx4 v249, s[32:35], s51 offen offset:1024 lds
  buffer_load_dwordx4 v250, s[28:31], s51 offen offset:2048 lds
  buffer_load_dwordx4 v251, s[32:35], s51 offen offset:3072 lds
  s_add_u32 s57, s57, 1
  s_cmp_eq_u32 s57, 7
  s_cselect_b32 s57, 0, s57
  s_mul_i32 s51, s57, 114688
  s_add_u32 s51, s51, s56
  s_lshl_b32 s74, s57, 12
  s_add_u32 m0, s74, s75
  s_nop 0
  buffer_load_dwordx4 v248, s[28:31], s51 offen offset:0 lds
  buffer_load_dwordx4 v249, s[32:35], s51 offen offset:1024 lds
  buffer_load_dwordx4 v250, s[28:31], s51 offen offset:2048 lds
  buffer_load_dwordx4 v251, s[32:35], s51 offen offset:3072 lds
  s_mov_b32 s72, 0
  s_lshl_b32 s73, s3, 1
  s_sub_u32 s73, s73, 1
  s_cmp_eq_u32 s3, 1
  s_cselect_b32 s73, 0, s73
  s_lshl_b32 s56, s88, 8
  s_lshl_b32 s75, s72, 6
  s_add_u32 s56, s56, s75
  s_mul_i32 s75, s72, 28672
  s_and_b32 s57, s87, 3
  s_lshl_b32 s57, s57, 1
  s_add_u32 s57, s57, s73
  s_cmp_ge_u32 s57, 7
  s_cselect_b32 s74, 7, 0
  s_sub_u32 s57, s57, s74
  s_mul_i32 s51, s57, 114688
  s_add_u32 s51, s51, s56
  s_lshl_b32 s74, s57, 12
  s_add_u32 m0, s74, s75
  s_nop 0
  buffer_load_dwordx4 v248, s[28:31], s51 offen offset:0 lds
  buffer_load_dwordx4 v249, s[32:35], s51 offen offset:1024 lds
  buffer_load_dwordx4 v250, s[28:31], s51 offen offset:2048 lds
  buffer_load_dwordx4 v251, s[32:35], s51 offen offset:3072 lds
  s_add_u32 s57, s57, 1
  s_cmp_eq_u32 s57, 7
  s_cselect_b32 s57, 0, s57
  s_mul_i32 s51, s57, 114688
  s_add_u32 s51, s51, s56
  s_lshl_b32 s74, s57, 12
  s_add_u32 m0, s74, s75
  s_nop 0
  buffer_load_dwordx4 v248, s[28:31], s51 offen offset:0 lds
  buffer_load_dwordx4 v249, s[32:35], s51 offen offset:1024 lds
  buffer_load_dwordx4 v250, s[28:31], s51 offen offset:2048 lds
  buffer_load_dwordx4 v251, s[32:35], s51 offen offset:3072 lds
  s_cmp_eq_u32 s3, 1
  s_cbranch_scc0 L_w3_10
  s_add_u32 s57, s57, 1
  s_cmp_eq_u32 s57, 7
  s_cselect_b32 s57, 0, s57
  s_mul_i32 s51, s57, 114688
  s_add_u32 s51, s51, s56
  s_lshl_b32 s74, s57, 12
  s_add_u32 m0, s74, s75
  s_nop 0
  buffer_load_dwordx4 v248, s[28:31], s51 offen offset:0 lds
  buffer_load_dwordx4 v249, s[32:35], s51 offen offset:1024 lds
  buffer_load_dwordx4 v250, s[28:31], s51 offen offset:2048 lds
  buffer_load_dwordx4 v251, s[32:35], s51 offen offset:3072 lds
L_w3_10:
  s_waitcnt vmcnt(0) lgkmcnt(0)
  s_branch L_wj_9
L_w0_8:
  s_lshr_b32 s76, s2, 5
  s_lshl_b32 s76, s76, 3
  s_and_b32 s77, s2, 7
  s_add_u32 s76, s76, s77
  s_lshl_b32 s76, s76, 8
  s_add_u32 s76, s76, 14745600
  v_mov_b32 v21, s76
  v_mov_b32 v22, 32
  s_mov_b32 s92, 40000
L_ploop_11:
  buffer_load_dword v23, v21, s[4:7], 0 offen sc1
  s_waitcnt vmcnt(0)
  v_cmp_lt_u32 vcc, v23, v22
  s_nop 4
  s_cbranch_vccz L_pdone_12
  s_sub_u32 s92, s92, 1
  s_cmp_lg_u32 s92, 0
  s_cbranch_scc0 L_pdone_12
  s_sleep 1
  s_branch L_ploop_11
L_pdone_12:
  s_lshl_b32 s76, s2, 13
  s_mov_b32 m0, 114688
  s_nop 0
  buffer_load_dwordx4 v9, s[4:7], s76 offen offset:0 sc1 lds
  buffer_load_dwordx4 v9, s[4:7], s76 offen offset:1024 sc1 lds
  buffer_load_dwordx4 v9, s[4:7], s76 offen offset:2048 sc1 lds
  buffer_load_dwordx4 v9, s[4:7], s76 offen offset:3072 sc1 lds
  s_add_u32 s76, s76, 4096
  s_mov_b32 m0, 119296
  s_nop 0
  buffer_load_dwordx4 v9, s[4:7], s76 offen offset:0 sc1 lds
  buffer_load_dwordx4 v9, s[4:7], s76 offen offset:1024 sc1 lds
  buffer_load_dwordx4 v9, s[4:7], s76 offen offset:2048 sc1 lds
  buffer_load_dwordx4 v9, s[4:7], s76 offen offset:3072 sc1 lds
  s_and_b32 s77, s2, 7
  s_lshl_b32 s77, s77, 8
  s_add_u32 s77, s77, 14759936
  v_mov_b32 v21, s77
  v_add_u32 v23, 4096, v21
  v_cmp_gt_u32 vcc, 32, v1
  s_nop 1
  v_cndmask_b32 v21, v23, v21, vcc
  s_waitcnt vmcnt(0) lgkmcnt(0)
L_wj_9:
  s_barrier
  ds_read_b128 v[64:67], v10 offset:3584
  ds_read_b128 v[68:71], v10 offset:3072
  ds_read_b128 v[72:75], v10 offset:2560
  ds_read_b128 v[76:79], v10 offset:2048
  ds_read_b128 v[80:83], v10 offset:1536
  ds_read_b128 v[84:87], v10 offset:1024
  ds_read_b128 v[88:91], v10 offset:512
  ds_read_b128 v[92:95], v10 offset:0
  s_and_b32 s76, s87, 3
  s_mul_i32 s76, s76, 200704
  s_lshl_b32 s77, s88, 8
  s_add_u32 s76, s76, s77
  s_lshr_b32 s77, s3, 1
  s_lshl_b32 s77, s77, 7
  s_add_u32 s76, s76, s77
  s_add_u32 s76, s76, 802816
  v_min_u32 v24, 55, v1
  v_mul_u32_u24 v24, 3584, v24
  s_bitcmp1_b32 s3, 0
  s_cbranch_scc1 L_wt_13
  buffer_load_dword v252, v24, s[28:31], s76 offen
  s_branch L_wtj_14
L_wt_13:
  buffer_load_dword v252, v24, s[32:35], s76 offen offset:1024
L_wtj_14:
  s_waitcnt lgkmcnt(0)
  v_mfma_f32_16x16x32_bf16 v[32:35], a[112:115], v[64:67], 0
  ds_read_b128 v[96:99], v10 offset:3648
  v_mfma_f32_16x16x32_bf16 v[36:39], a[112:115], v[68:71], 0
  ds_read_b128 v[100:103], v10 offset:3136
  v_mfma_f32_16x16x32_bf16 v[40:43], a[112:115], v[72:75], 0
  ds_read_b128 v[104:107], v10 offset:2624
  v_mfma_f32_16x16x32_bf16 v[44:47], a[112:115], v[76:79], 0
  ds_read_b128 v[108:111], v10 offset:2112
  v_mfma_f32_16x16x32_bf16 v[48:51], a[112:115], v[80:83], 0
  ds_read_b128 v[112:115], v10 offset:1600
  v_mfma_f32_16x16x32_bf16 v[52:55], a[112:115], v[84:87], 0
  ds_read_b128 v[116:119], v10 offset:1088
  v_mfma_f32_16x16x32_bf16 v[56:59], a[112:115], v[88:91], 0
  ds_read_b128 v[120:123], v10 offset:576
  v_mfma_f32_16x16x32_bf16 v[60:63], a[112:115], v[92:95], 0
  ds_read_b128 v[124:127], v10 offset:64
  v_mfma_f32_16x16x32_bf16 v[36:39], a[116:119], v[64:67], v[36:39]
  ds_read_b64_tr_b16 a[0:1], v246 offset:0
  ds_read_b64_tr_b16 a[2:3], v246 offset:256
  v_mfma_f32_16x16x32_bf16 v[40:43], a[116:119], v[68:71], v[40:43]
  ds_read_b64_tr_b16 a[4:5], v247 offset:0
  ds_read_b64_tr_b16 a[6:7], v247 offset:256
  v_mfma_f32_16x16x32_bf16 v[44:47], a[116:119], v[72:75], v[44:47]
  ds_read_b64_tr_b16 a[8:9], v246 offset:2048
  ds_read_b64_tr_b16 a[10:11], v246 offset:2304
  v_mfma_f32_16x16x32_bf16 v[48:51], a[116:119], v[76:79], v[48:51]
  ds_read_b64_tr_b16 a[12:13], v247 offset:2048
  ds_read_b64_tr_b16 a[14:15], v247 offset:2304
  v_mfma_f32_16x16x32_bf16 v[52:55], a[116:119], v[80:83], v[52:55]
  ds_read_b64_tr_b16 a[16:17], v246 offset:4096
  ds_read_b64_tr_b16 a[18:19], v246 offset:4352
  v_mfma_f32_16x16x32_bf16 v[56:59], a[116:119], v[84:87], v[56:59]
  ds_read_b64_tr_b16 a[20:21], v247 offset:4096
  ds_read_b64_tr_b16 a[22:23], v247 offset:4352
  v_mfma_f32_16x16x32_bf16 v[60:63], a[116:119], v[88:91], v[60:63]
  ds_read_b64_tr_b16 a[24:25], v246 offset:6144
  ds_read_b64_tr_b16 a[26:27], v246 offset:6400
  v_mfma_f32_16x16x32_bf16 v[40:43], a[120:123], v[64:67], v[40:43]
  ds_read_b64_tr_b16 a[28:29], v247 offset:6144
  ds_read_b64_tr_b16 a[30:31], v247 offset:6400
  v_mfma_f32_16x16x32_bf16 v[44:47], a[120:123], v[68:71], v[44:47]
  ds_read_b64_tr_b16 a[32:33], v246 offset:8192
  ds_read_b64_tr_b16 a[34:35], v246 offset:8448
  v_mfma_f32_16x16x32_bf16 v[48:51], a[120:123], v[72:75], v[48:51]
  ds_read_b64_tr_b16 a[36:37], v247 offset:8192
  ds_read_b64_tr_b16 a[38:39], v247 offset:8448
  v_mfma_f32_16x16x32_bf16 v[52:55], a[120:123], v[76:79], v[52:55]
  ds_read_b64_tr_b16 a[40:41], v246 offset:10240
  ds_read_b64_tr_b16 a[42:43], v246 offset:10496
  v_mfma_f32_16x16x32_bf16 v[56:59], a[120:123], v[80:83], v[56:59]
  ds_read_b64_tr_b16 a[44:45], v247 offset:10240
  ds_read_b64_tr_b16 a[46:47], v247 offset:10496
  v_mfma_f32_16x16x32_bf16 v[60:63], a[120:123], v[84:87], v[60:63]
  ds_read_b64_tr_b16 a[48:49], v246 offset:12288
  ds_read_b64_tr_b16 a[50:51], v246 offset:12544
  v_mfma_f32_16x16x32_bf16 v[44:47], a[124:127], v[64:67], v[44:47]
  ds_read_b64_tr_b16 a[52:53], v247 offset:12288
  ds_read_b64_tr_b16 a[54:55], v247 offset:12544
  v_mfma_f32_16x16x32_bf16 v[48:51], a[124:127], v[68:71], v[48:51]
  ds_read_b64_tr_b16 a[56:57], v246 offset:14336
  ds_read_b64_tr_b16 a[58:59], v246 offset:14592
  v_mfma_f32_16x16x32_bf16 v[52:55], a[124:127], v[72:75], v[52:55]
  ds_read_b64_tr_b16 a[60:61], v247 offset:14336
  ds_read_b64_tr_b16 a[62:63], v247 offset:14592
  v_mfma_f32_16x16x32_bf16 v[56:59], a[124:127], v[76:79], v[56:59]
  ds_read_b64_tr_b16 a[64:65], v246 offset:16384
  ds_read_b64_tr_b16 a[66:67], v246 offset:16640
  v_mfma_f32_16x16x32_bf16 v[60:63], a[124:127], v[80:83], v[60:63]
  ds_read_b64_tr_b16 a[68:69], v247 offset:16384
  ds_read_b64_tr_b16 a[70:71], v247 offset:16640
  v_mfma_f32_16x16x32_bf16 v[48:51], a[128:131], v[64:67], v[48:51]
  ds_read_b64_tr_b16 a[72:73], v246 offset:18432
  ds_read_b64_tr_b16 a[74:75], v246 offset:18688
  v_mfma_f32_16x16x32_bf16 v[52:55], a[128:131], v[68:71], v[52:55]
  ds_read_b64_tr_b16 a[76:77], v247 offset:18432
  ds_read_b64_tr_b16 a[78:79], v247 offset:18688
  v_mfma_f32_16x16x32_bf16 v[56:59], a[128:131], v[72:75], v[56:59]
  ds_read_b64_tr_b16 a[80:81], v246 offset:20480
  ds_read_b64_tr_b16 a[82:83], v246 offset:20736
  v_mfma_f32_16x16x32_bf16 v[60:63], a[128:131], v[76:79], v[60:63]
  ds_read_b64_tr_b16 a[84:85], v247 offset:20480
  ds_read_b64_tr_b16 a[86:87], v247 offset:20736
  v_mfma_f32_16x16x32_bf16 v[52:55], a[132:135], v[64:67], v[52:55]
  ds_read_b64_tr_b16 a[88:89], v246 offset:22528
  ds_read_b64_tr_b16 a[90:91], v246 offset:22784
  v_mfma_f32_16x16x32_bf16 v[56:59], a[132:135], v[68:71], v[56:59]
  ds_read_b64_tr_b16 a[92:93], v247 offset:22528
  ds_read_b64_tr_b16 a[94:95], v247 offset:22784
  v_mfma_f32_16x16x32_bf16 v[60:63], a[132:135], v[72:75], v[60:63]
  ds_read_b64_tr_b16 a[96:97], v246 offset:24576
  ds_read_b64_tr_b16 a[98:99], v246 offset:24832
  v_mfma_f32_16x16x32_bf16 v[56:59], a[136:139], v[64:67], v[56:59]
  ds_read_b64_tr_b16 a[100:101], v247 offset:24576
  ds_read_b64_tr_b16 a[102:103], v247 offset:24832
  v_mfma_f32_16x16x32_bf16 v[60:63], a[136:139], v[68:71], v[60:63]
  ds_read_b64_tr_b16 a[104:105], v246 offset:26624
  ds_read_b64_tr_b16 a[106:107], v246 offset:26880
  v_mfma_f32_16x16x32_bf16 v[60:63], a[140:143], v[64:67], v[60:63]
  ds_read_b64_tr_b16 a[108:109], v247 offset:26624
  ds_read_b64_tr_b16 a[110:111], v247 offset:26880
  s_cmp_eq_u32 s3, 0
  s_cbranch_scc0 L_sl_15
  buffer_load_dword v23, v21, s[4:7], 0 offen sc1
L_sl_15:
  s_waitcnt lgkmcnt(15)
  v_mfma_f32_16x16x32_bf16 v[32:35], a[144:147], v[96:99], v[32:35]
  ds_read_b128 v[64:67], v10 offset:3712
  v_mfma_f32_16x16x32_bf16 v[36:39], a[144:147], v[100:103], v[36:39]
  ds_read_b128 v[68:71], v10 offset:3200
  v_mfma_f32_16x16x32_bf16 v[40:43], a[144:147], v[104:107], v[40:43]
  ds_read_b128 v[72:75], v10 offset:2688
  v_mfma_f32_16x16x32_bf16 v[44:47], a[144:147], v[108:111], v[44:47]
  ds_read_b128 v[76:79], v10 offset:2176
  v_mfma_f32_16x16x32_bf16 v[48:51], a[144:147], v[112:115], v[48:51]
  ds_read_b128 v[80:83], v10 offset:1664
  v_mfma_f32_16x16x32_bf16 v[52:55], a[144:147], v[116:119], v[52:55]
  ds_read_b128 v[84:87], v10 offset:1152
  v_mfma_f32_16x16x32_bf16 v[56:59], a[144:147], v[120:123], v[56:59]
  ds_read_b128 v[88:91], v10 offset:640
  v_mfma_f32_16x16x32_bf16 v[60:63], a[144:147], v[124:127], v[60:63]
  ds_read_b128 v[92:95], v10 offset:128
  v_mfma_f32_16x16x32_bf16 v[36:39], a[148:151], v[96:99], v[36:39]
  ds_read_b64 v[136:137], v11 offset:1536
  buffer_load_dwordx2 v[128:129], v6, s[4:7], 0 offen offset:0 sc1
  v_mfma_f32_16x16x32_bf16 v[40:43], a[148:151], v[100:103], v[40:43]
  ds_read_b64 v[138:139], v11 offset:1024
  buffer_load_dwordx2 v[130:131], v6, s[4:7], 0 offen offset:512 sc1
  v_mfma_f32_16x16x32_bf16 v[44:47], a[148:151], v[104:107], v[44:47]
  ds_read_b64 v[140:141], v11 offset:512
  buffer_load_dwordx2 v[132:133], v6, s[4:7], 0 offen offset:1024 sc1
  v_mfma_f32_16x16x32_bf16 v[48:51], a[148:151], v[108:111], v[48:51]
  ds_read_b64 v[142:143], v11 offset:0
  buffer_load_dwordx2 v[134:135], v6, s[4:7], 0 offen offset:1536 sc1
  v_mfma_f32_16x16x32_bf16 v[52:55], a[148:151], v[112:115], v[52:55]
  s_waitcnt lgkmcnt(12)
  s_lshl_b32 s56, s88, 8
  s_lshl_b32 s75, s3, 6
  s_add_u32 s56, s56, s75
  s_add_u32 s56, s56, 802816
  s_mul_i32 s75, s3, 28672
  s_and_b32 s57, s87, 3
  s_lshl_b32 s57, s57, 1
  s_mul_i32 s51, s57, 114688
  s_add_u32 s51, s51, s56
  s_lshl_b32 s74, s57, 12
  s_add_u32 m0, s74, s75
  s_nop 0
  buffer_load_dwordx4 v248, s[28:31], s51 offen offset:0 lds
  v_mfma_f32_16x16x32_bf16 v[56:59], a[148:151], v[116:119], v[56:59]
  s_waitcnt lgkmcnt(0)
  v_and_b32 v192, 0xffff0000, v137
  v_mfma_f32_16x16x32_bf16 v[60:63], a[148:151], v[120:123], v[60:63]
  buffer_load_dwordx4 v249, s[32:35], s51 offen offset:1024 lds
  v_mfma_f32_16x16x32_bf16 v[40:43], a[152:155], v[96:99], v[40:43]
  v_lshlrev_b32 v193, 16, v137
  v_mfma_f32_16x16x32_bf16 v[44:47], a[152:155], v[100:103], v[44:47]
  v_and_b32 v194, 0xffff0000, v136
  v_mfma_f32_16x16x32_bf16 v[48:51], a[152:155], v[104:107], v[48:51]
  buffer_load_dwordx4 v250, s[28:31], s51 offen offset:2048 lds
  v_mfma_f32_16x16x32_bf16 v[52:55], a[152:155], v[108:111], v[52:55]
  v_lshlrev_b32 v195, 16, v136
  v_mfma_f32_16x16x32_bf16 v[56:59], a[152:155], v[112:115], v[56:59]
  v_and_b32 v196, 0xffff0000, v139
  v_mfma_f32_16x16x32_bf16 v[60:63], a[152:155], v[116:119], v[60:63]
  buffer_load_dwordx4 v251, s[32:35], s51 offen offset:3072 lds
  v_mfma_f32_16x16x32_bf16 v[44:47], a[156:159], v[96:99], v[44:47]
  v_lshlrev_b32 v197, 16, v139
  v_mfma_f32_16x16x32_bf16 v[48:51], a[156:159], v[100:103], v[48:51]
  v_and_b32 v198, 0xffff0000, v138
  v_mfma_f32_16x16x32_bf16 v[52:55], a[156:159], v[104:107], v[52:55]
  s_add_u32 s57, s57, 1
  s_cmp_eq_u32 s57, 7
  s_cselect_b32 s57, 0, s57
  s_mul_i32 s51, s57, 114688
  s_add_u32 s51, s51, s56
  s_lshl_b32 s74, s57, 12
  s_add_u32 m0, s74, s75
  s_nop 0
  buffer_load_dwordx4 v248, s[28:31], s51 offen offset:0 lds
  v_mfma_f32_16x16x32_bf16 v[56:59], a[156:159], v[108:111], v[56:59]
  v_lshlrev_b32 v199, 16, v138
  v_mfma_f32_16x16x32_bf16 v[60:63], a[156:159], v[112:115], v[60:63]
  v_and_b32 v200, 0xffff0000, v141
  v_mfma_f32_16x16x32_bf16 v[48:51], a[160:163], v[96:99], v[48:51]
  buffer_load_dwordx4 v249, s[32:35], s51 offen offset:1024 lds
  v_mfma_f32_16x16x32_bf16 v[52:55], a[160:163], v[100:103], v[52:55]
  v_lshlrev_b32 v201, 16, v141
  v_mfma_f32_16x16x32_bf16 v[56:59], a[160:163], v[104:107], v[56:59]
  v_and_b32 v202, 0xffff0000, v140
  v_mfma_f32_16x16x32_bf16 v[60:63], a[160:163], v[108:111], v[60:63]
  buffer_load_dwordx4 v250, s[28:31], s51 offen offset:2048 lds
  v_mfma_f32_16x16x32_bf16 v[52:55], a[164:167], v[96:99], v[52:55]
  v_lshlrev_b32 v203, 16, v140
  v_mfma_f32_16x16x32_bf16 v[56:59], a[164:167], v[100:103], v[56:59]
  v_and_b32 v204, 0xffff0000, v143
  v_mfma_f32_16x16x32_bf16 v[60:63], a[164:167], v[104:107], v[60:63]
  buffer_load_dwordx4 v251, s[32:35], s51 offen offset:3072 lds
  v_mfma_f32_16x16x32_bf16 v[56:59], a[168:171], v[96:99], v[56:59]
  v_lshlrev_b32 v205, 16, v143
  v_mfma_f32_16x16x32_bf16 v[60:63], a[168:171], v[100:103], v[60:63]
  v_and_b32 v206, 0xffff0000, v142
  v_mfma_f32_16x16x32_bf16 v[60:63], a[172:175], v[96:99], v[60:63]
  v_lshlrev_b32 v207, 16, v142
  s_waitcnt vmcnt(12)
  s_cmp_eq_u32 s3, 0
  s_cbranch_scc0 L_sld_17
  s_mov_b32 s92, 40000
L_sll_16:
  v_cmp_lt_u32 vcc, v23, v22
  s_nop 4
  s_cbranch_vccz L_sld_17
  buffer_load_dword v23, v21, s[4:7], 0 offen sc1
  s_waitcnt vmcnt(0)
  s_sub_u32 s92, s92, 1
  s_cmp_lg_u32 s92, 0
  s_cbranch_scc1 L_sll_16
L_sld_17:
  s_barrier
  v_mfma_f32_16x16x32_bf16 v[32:35], a[176:179], v[64:67], v[32:35]
  ds_read_b128 v[96:99], v10 offset:3776
  v_mfma_f32_16x16x32_bf16 v[36:39], a[176:179], v[68:71], v[36:39]
  ds_read_b128 v[100:103], v10 offset:3264
  v_mfma_f32_16x16x32_bf16 v[40:43], a[176:179], v[72:75], v[40:43]
  ds_read_b128 v[104:107], v10 offset:2752
  v_mfma_f32_16x16x32_bf16 v[44:47], a[176:179], v[76:79], v[44:47]
  ds_read_b128 v[108:111], v10 offset:2240
  v_mfma_f32_16x16x32_bf16 v[48:51], a[176:179], v[80:83], v[48:51]
  ds_read_b128 v[112:115], v10 offset:1728
  v_mfma_f32_16x16x32_bf16 v[52:55], a[176:179], v[84:87], v[52:55]
  ds_read_b128 v[116:119], v10 offset:1216
  v_mfma_f32_16x16x32_bf16 v[56:59], a[176:179], v[88:91], v[56:59]
  ds_read_b128 v[120:123], v10 offset:704
  v_mfma_f32_16x16x32_bf16 v[60:63], a[176:179], v[92:95], v[60:63]
  ds_read_b128 v[124:127], v10 offset:192
  v_mfma_f32_16x16x32_bf16 v[36:39], a[180:183], v[64:67], v[36:39]
  s_lshl_b32 s80, s3, 12
  s_add_u32 m0, s80, 123904
  s_add_u32 s80, s80, 14680064
  buffer_load_dwordx4 v9, s[4:7], s80 offen offset:0 sc1 lds
  buffer_load_dwordx4 v9, s[4:7], s80 offen offset:1024 sc1 lds
  buffer_load_dwordx4 v9, s[4:7], s80 offen offset:2048 sc1 lds
  buffer_load_dwordx4 v9, s[4:7], s80 offen offset:3072 sc1 lds
  v_mfma_f32_16x16x32_bf16 v[40:43], a[180:183], v[68:71], v[40:43]
  s_add_u32 s57, s57, 1
  s_cmp_eq_u32 s57, 7
  s_cselect_b32 s57, 0, s57
  s_mul_i32 s51, s57, 114688
  s_add_u32 s51, s51, s56
  s_lshl_b32 s74, s57, 12
  s_add_u32 m0, s74, s75
  s_nop 0
  buffer_load_dwordx4 v248, s[28:31], s51 offen offset:0 lds
  v_mfma_f32_16x16x32_bf16 v[44:47], a[180:183], v[72:75], v[44:47]
  v_mul_f32 v192, s50, v192
  v_mfma_f32_16x16x32_bf16 v[48:51], a[180:183], v[76:79], v[48:51]
  v_mul_f32 v193, s50, v193
  v_mfma_f32_16x16x32_bf16 v[52:55], a[180:183], v[80:83], v[52:55]
  buffer_load_dwordx4 v249, s[32:35], s51 offen offset:1024 lds
  v_mfma_f32_16x16x32_bf16 v[56:59], a[180:183], v[84:87], v[56:59]
  v_mul_f32 v194, s50, v194
  v_mfma_f32_16x16x32_bf16 v[60:63], a[180:183], v[88:91], v[60:63]
  v_mul_f32 v195, s50, v195
  v_mfma_f32_16x16x32_bf16 v[40:43], a[184:187], v[64:67], v[40:43]
  buffer_load_dwordx4 v250, s[28:31], s51 offen offset:2048 lds
  v_mfma_f32_16x16x32_bf16 v[44:47], a[184:187], v[68:71], v[44:47]
  v_mul_f32 v196, s50, v196
  v_mfma_f32_16x16x32_bf16 v[48:51], a[184:187], v[72:75], v[48:51]
  v_mul_f32 v197, s50, v197
  v_mfma_f32_16x16x32_bf16 v[52:55], a[184:187], v[76:79], v[52:55]
  buffer_load_dwordx4 v251, s[32:35], s51 offen offset:3072 lds
  v_mfma_f32_16x16x32_bf16 v[56:59], a[184:187], v[80:83], v[56:59]
  v_mul_f32 v198, s50, v198
  v_mfma_f32_16x16x32_bf16 v[60:63], a[184:187], v[84:87], v[60:63]
  v_mul_f32 v199, s50, v199
  v_mfma_f32_16x16x32_bf16 v[44:47], a[188:191], v[64:67], v[44:47]
  v_mul_f32 v200, s50, v200
  v_mfma_f32_16x16x32_bf16 v[48:51], a[188:191], v[68:71], v[48:51]
  s_add_u32 s57, s57, 1
  s_cmp_eq_u32 s57, 7
  s_cselect_b32 s57, 0, s57
  s_mul_i32 s51, s57, 114688
  s_add_u32 s51, s51, s56
  s_lshl_b32 s74, s57, 12
  s_add_u32 m0, s74, s75
  s_nop 0
  buffer_load_dwordx4 v248, s[28:31], s51 offen offset:0 lds
  v_mfma_f32_16x16x32_bf16 v[52:55], a[188:191], v[72:75], v[52:55]
  v_mul_f32 v201, s50, v201
  v_mfma_f32_16x16x32_bf16 v[56:59], a[188:191], v[76:79], v[56:59]
  v_mul_f32 v202, s50, v202
  v_mfma_f32_16x16x32_bf16 v[60:63], a[188:191], v[80:83], v[60:63]
  buffer_load_dwordx4 v249, s[32:35], s51 offen offset:1024 lds
  v_mfma_f32_16x16x32_bf16 v[48:51], a[192:195], v[64:67], v[48:51]
  v_mul_f32 v203, s50, v203
  v_mfma_f32_16x16x32_bf16 v[52:55], a[192:195], v[68:71], v[52:55]
  v_mul_f32 v204, s50, v204
  v_mfma_f32_16x16x32_bf16 v[56:59], a[192:195], v[72:75], v[56:59]
  buffer_load_dwordx4 v250, s[28:31], s51 offen offset:2048 lds
  v_mfma_f32_16x16x32_bf16 v[60:63], a[192:195], v[76:79], v[60:63]
  v_mul_f32 v205, s50, v205
  v_mfma_f32_16x16x32_bf16 v[52:55], a[196:199], v[64:67], v[52:55]
  v_mul_f32 v206, s50, v206
  v_mfma_f32_16x16x32_bf16 v[56:59], a[196:199], v[68:71], v[56:59]
  buffer_load_dwordx4 v251, s[32:35], s51 offen offset:3072 lds
  v_mul_f32 v207, s50, v207
  v_mfma_f32_16x16x32_bf16 v[60:63], a[196:199], v[72:75], v[60:63]
  s_waitcnt vmcnt(20)
  v_lshlrev_b32 v208, 16, v128
  v_mfma_f32_16x16x32_bf16 v[56:59], a[200:203], v[64:67], v[56:59]
  v_and_b32 v209, 0xffff0000, v128
  v_mfma_f32_16x16x32_bf16 v[60:63], a[200:203], v[68:71], v[60:63]
  v_lshlrev_b32 v210, 16, v129
  v_mfma_f32_16x16x32_bf16 v[60:63], a[204:207], v[64:67], v[60:63]
  v_and_b32 v211, 0xffff0000, v129
  s_waitcnt vmcnt(8)
  s_barrier
  s_waitcnt lgkmcnt(0)
  v_mfma_f32_16x16x32_bf16 v[32:35], a[208:211], v[96:99], v[32:35]
  s_add_u32 s57, s57, 1
  s_cmp_eq_u32 s57, 7
  s_cselect_b32 s57, 0, s57
  s_mul_i32 s51, s57, 114688
  s_add_u32 s51, s51, s56
  s_lshl_b32 s74, s57, 12
  s_add_u32 m0, s74, s75
  s_nop 0
  buffer_load_dwordx4 v248, s[28:31], s51 offen offset:0 lds
  v_mfma_f32_16x16x32_bf16 v[36:39], a[208:211], v[100:103], v[36:39]
  ds_read_b128 v[144:147], v16 offset:0
  ds_read_b128 v[160:163], v16 offset:8192
  v_mfma_f32_16x16x32_bf16 v[40:43], a[208:211], v[104:107], v[40:43]
  buffer_load_dwordx4 v249, s[32:35], s51 offen offset:1024 lds
  v_mfma_f32_16x16x32_bf16 v[44:47], a[208:211], v[108:111], v[44:47]
  ds_read_b128 v[148:151], v16 offset:1024
  ds_read_b128 v[164:167], v16 offset:9216
  v_mfma_f32_16x16x32_bf16 v[48:51], a[208:211], v[112:115], v[48:51]
  ds_read_b128 v[152:155], v16 offset:2048
  ds_read_b128 v[168:171], v16 offset:10240
  v_mfma_f32_16x16x32_bf16 v[52:55], a[208:211], v[116:119], v[52:55]
  buffer_load_dwordx4 v250, s[28:31], s51 offen offset:2048 lds
  v_mfma_f32_16x16x32_bf16 v[56:59], a[208:211], v[120:123], v[56:59]
  ds_read_b128 v[156:159], v16 offset:3072
  ds_read_b128 v[172:175], v16 offset:11264
  v_mfma_f32_16x16x32_bf16 v[60:63], a[208:211], v[124:127], v[60:63]
  v_lshlrev_b32 v212, 16, v130
  v_mfma_f32_16x16x32_bf16 v[36:39], a[212:215], v[96:99], v[36:39]
  buffer_load_dwordx4 v251, s[32:35], s51 offen offset:3072 lds
  v_mfma_f32_16x16x32_bf16 v[40:43], a[212:215], v[100:103], v[40:43]
  v_and_b32 v213, 0xffff0000, v130
  v_mfma_f32_16x16x32_bf16 v[44:47], a[212:215], v[104:107], v[44:47]
  v_lshlrev_b32 v214, 16, v131
  v_mfma_f32_16x16x32_bf16 v[48:51], a[212:215], v[108:111], v[48:51]
  s_add_u32 s57, s57, 1
  s_cmp_eq_u32 s57, 7
  s_cselect_b32 s57, 0, s57
  s_mul_i32 s51, s57, 114688
  s_add_u32 s51, s51, s56
  s_lshl_b32 s74, s57, 12
  s_add_u32 m0, s74, s75
  s_nop 0
  buffer_load_dwordx4 v248, s[28:31], s51 offen offset:0 lds
  v_and_b32 v215, 0xffff0000, v131
  v_mfma_f32_16x16x32_bf16 v[52:55], a[212:215], v[112:115], v[52:55]
  v_lshlrev_b32 v216, 16, v132
  v_mfma_f32_16x16x32_bf16 v[56:59], a[212:215], v[116:119], v[56:59]
  v_and_b32 v217, 0xffff0000, v132
  v_mfma_f32_16x16x32_bf16 v[60:63], a[212:215], v[120:123], v[60:63]
  buffer_load_dwordx4 v249, s[32:35], s51 offen offset:1024 lds
  v_lshlrev_b32 v218, 16, v133
  v_mfma_f32_16x16x32_bf16 v[40:43], a[216:219], v[96:99], v[40:43]
  v_and_b32 v219, 0xffff0000, v133
  v_mfma_f32_16x16x32_bf16 v[44:47], a[216:219], v[100:103], v[44:47]
  v_lshlrev_b32 v220, 16, v134
  v_mfma_f32_16x16x32_bf16 v[48:51], a[216:219], v[104:107], v[48:51]
  buffer_load_dwordx4 v250, s[28:31], s51 offen offset:2048 lds
  v_and_b32 v221, 0xffff0000, v134
  v_mfma_f32_16x16x32_bf16 v[52:55], a[216:219], v[108:111], v[52:55]
  v_lshlrev_b32 v222, 16, v135
  v_mfma_f32_16x16x32_bf16 v[56:59], a[216:219], v[112:115], v[56:59]
  v_and_b32 v223, 0xffff0000, v135
  v_mfma_f32_16x16x32_bf16 v[60:63], a[216:219], v[116:119], v[60:63]
  buffer_load_dwordx4 v251, s[32:35], s51 offen offset:3072 lds
  s_waitcnt lgkmcnt(0)
  v_fma_f32 v176, v208, v144, v160
  v_mfma_f32_16x16x32_bf16 v[44:47], a[220:223], v[96:99], v[44:47]
  v_fma_f32 v177, v209, v145, v161
  v_mfma_f32_16x16x32_bf16 v[48:51], a[220:223], v[100:103], v[48:51]
  v_fma_f32 v178, v210, v146, v162
  v_mfma_f32_16x16x32_bf16 v[52:55], a[220:223], v[104:107], v[52:55]
  s_add_u32 s57, s57, 1
  s_cmp_eq_u32 s57, 7
  s_cselect_b32 s57, 0, s57
  s_mul_i32 s51, s57, 114688
  s_add_u32 s51, s51, s56
  s_lshl_b32 s74, s57, 12
  s_add_u32 m0, s74, s75
  s_nop 0
  buffer_load_dwordx4 v248, s[28:31], s51 offen offset:0 lds
  v_fma_f32 v179, v211, v147, v163
  v_mfma_f32_16x16x32_bf16 v[56:59], a[220:223], v[108:111], v[56:59]
  v_fma_f32 v180, v212, v148, v164
  v_mfma_f32_16x16x32_bf16 v[60:63], a[220:223], v[112:115], v[60:63]
  v_fma_f32 v181, v213, v149, v165
  v_mfma_f32_16x16x32_bf16 v[48:51], a[224:227], v[96:99], v[48:51]
  buffer_load_dwordx4 v249, s[32:35], s51 offen offset:1024 lds
  v_fma_f32 v182, v214, v150, v166
  v_mfma_f32_16x16x32_bf16 v[52:55], a[224:227], v[100:103], v[52:55]
  v_fma_f32 v183, v215, v151, v167
  v_mfma_f32_16x16x32_bf16 v[56:59], a[224:227], v[104:107], v[56:59]
  v_fma_f32 v184, v216, v152, v168
  v_mfma_f32_16x16x32_bf16 v[60:63], a[224:227], v[108:111], v[60:63]
  buffer_load_dwordx4 v250, s[28:31], s51 offen offset:2048 lds
  v_fma_f32 v185, v217, v153, v169
  v_mfma_f32_16x16x32_bf16 v[52:55], a[228:231], v[96:99], v[52:55]
  v_fma_f32 v186, v218, v154, v170
  v_mfma_f32_16x16x32_bf16 v[56:59], a[228:231], v[100:103], v[56:59]
  v_fma_f32 v187, v219, v155, v171
  v_mfma_f32_16x16x32_bf16 v[60:63], a[228:231], v[104:107], v[60:63]
  buffer_load_dwordx4 v251, s[32:35], s51 offen offset:3072 lds
  v_fma_f32 v188, v220, v156, v172
  v_mfma_f32_16x16x32_bf16 v[56:59], a[232:235], v[96:99], v[56:59]
  v_fma_f32 v189, v221, v157, v173
  v_mfma_f32_16x16x32_bf16 v[60:63], a[232:235], v[100:103], v[60:63]
  v_fma_f32 v190, v222, v158, v174
  v_mfma_f32_16x16x32_bf16 v[60:63], a[236:239], v[96:99], v[60:63]
  v_fma_f32 v191, v223, v159, v175
  s_lshr_b32 s76, s2, 3
  s_mul_i32 s76, s76, 448
  s_mul_i32 s77, s3, 112
  s_add_u32 s76, s76, s77
  s_lshl_b32 s76, s76, 7
  v_min_u32 v24, 55, v1
  v_lshlrev_b32 v24, 7, v24
  buffer_load_dword v252, v24, s[36:39], s76 offen
  s_nop 7
  s_cmp_eq_u32 s98, 0
  s_cbranch_scc0 L_h1_18
  ds_write_b128 v12, v[48:51] offset:0
  ds_write_b128 v12, v[52:55] offset:1024
  ds_write_b128 v12, v[56:59] offset:2048
  ds_write_b128 v12, v[60:63] offset:3072
  v_add_f32 v224, v32, v192
  v_add_f32 v225, v33, v193
  v_add_f32 v226, v34, v194
  v_add_f32 v227, v35, v195
  v_add_f32 v228, v36, v196
  v_add_f32 v229, v37, v197
  v_add_f32 v230, v38, v198
  v_add_f32 v231, v39, v199
  v_add_f32 v232, v40, v200
  v_add_f32 v233, v41, v201
  v_add_f32 v234, v42, v202
  v_add_f32 v235, v43, v203
  v_add_f32 v236, v44, v204
  v_add_f32 v237, v45, v205
  v_add_f32 v238, v46, v206
  v_add_f32 v239, v47, v207
  s_branch L_hj_19
L_h1_18:
  ds_write_b128 v12, v[32:35] offset:0
  ds_write_b128 v12, v[36:39] offset:1024
  ds_write_b128 v12, v[40:43] offset:2048
  ds_write_b128 v12, v[44:47] offset:3072
  v_add_f32 v224, v48, v192
  v_add_f32 v225, v49, v193
  v_add_f32 v226, v50, v194
  v_add_f32 v227, v51, v195
  v_add_f32 v228, v52, v196
  v_add_f32 v229, v53, v197
  v_add_f32 v230, v54, v198
  v_add_f32 v231, v55, v199
  v_add_f32 v232, v56, v200
  v_add_f32 v233, v57, v201
  v_add_f32 v234, v58, v202
  v_add_f32 v235, v59, v203
  v_add_f32 v236, v60, v204
  v_add_f32 v237, v61, v205
  v_add_f32 v238, v62, v206
  v_add_f32 v239, v63, v207
L_hj_19:
  s_waitcnt lgkmcnt(0)
  s_barrier
  ds_read_b128 v[64:67], v13 offset:0
  ds_read_b128 v[68:71], v13 offset:1024
  ds_read_b128 v[72:75], v13 offset:2048
  ds_read_b128 v[76:79], v13 offset:3072
  s_waitcnt lgkmcnt(3)
  v_add_f32 v224, v224, v64
  v_add_f32 v225, v225, v65
  v_add_f32 v226, v226, v66
  v_add_f32 v227, v227, v67
  v_fma_f32 v224, v176, v224, v208
  v_fma_f32 v225, v177, v225, v209
  v_fma_f32 v226, v178, v226, v210
  v_fma_f32 v227, v179, v227, v211
  v_cvt_pk_bf16_f32 v80, v224, v225
  v_cvt_pk_bf16_f32 v81, v226, v227
  s_waitcnt lgkmcnt(2)
  v_add_f32 v228, v228, v68
  v_add_f32 v229, v229, v69
  v_add_f32 v230, v230, v70
  v_add_f32 v231, v231, v71
  v_fma_f32 v228, v180, v228, v212
  v_fma_f32 v229, v181, v229, v213
  v_fma_f32 v230, v182, v230, v214
  v_fma_f32 v231, v183, v231, v215
  v_cvt_pk_bf16_f32 v82, v228, v229
  v_cvt_pk_bf16_f32 v83, v230, v231
  s_nop 1
  v_permlane16_swap_b32 v80, v82
  v_permlane16_swap_b32 v81, v83
  buffer_store_dwordx4 v[80:83], v14, s[4:7], s82 offen sc1
  s_waitcnt lgkmcnt(1)
  v_add_f32 v232, v232, v72
  v_add_f32 v233, v233, v73
  v_add_f32 v234, v234, v74
  v_add_f32 v235, v235, v75
  v_fma_f32 v232, v184, v232, v216
  v_fma_f32 v233, v185, v233, v217
  v_fma_f32 v234, v186, v234, v218
  v_fma_f32 v235, v187, v235, v219
  v_cvt_pk_bf16_f32 v84, v232, v233
  v_cvt_pk_bf16_f32 v85, v234, v235
  s_waitcnt lgkmcnt(0)
  v_add_f32 v236, v236, v76
  v_add_f32 v237, v237, v77
  v_add_f32 v238, v238, v78
  v_add_f32 v239, v239, v79
  v_fma_f32 v236, v188, v236, v220
  v_fma_f32 v237, v189, v237, v221
  v_fma_f32 v238, v190, v238, v222
  v_fma_f32 v239, v191, v239, v223
  v_cvt_pk_bf16_f32 v86, v236, v237
  v_cvt_pk_bf16_f32 v87, v238, v239
  s_nop 1
  v_permlane16_swap_b32 v84, v86
  v_permlane16_swap_b32 v85, v87
  buffer_store_dwordx4 v[84:87], v14, s[4:7], s83 offen sc1
  v_mov_b32 v108, 0x3f803f80
  v_mov_b32 v109, 0x3f803f80
  v_mov_b32 v110, 0x3f803f80
  v_mov_b32 v111, 0x3f803f80
  s_waitcnt vmcnt(3)
  s_nop 1
  v_mfma_f32_32x32x16_bf16 v[64:79], v[108:111], a[0:3], 0
  ds_read_b64_tr_b16 a[112:113], v246 offset:0
  ds_read_b64_tr_b16 a[114:115], v246 offset:256
  v_mfma_f32_32x32x16_bf16 v[80:95], v[108:111], a[4:7], 0
  ds_read_b64_tr_b16 a[116:117], v247 offset:0
  ds_read_b64_tr_b16 a[118:119], v247 offset:256
  v_mfma_f32_32x32x16_bf16 v[64:79], v[108:111], a[8:11], v[64:79]
  ds_read_b64_tr_b16 a[120:121], v246 offset:2048
  ds_read_b64_tr_b16 a[122:123], v246 offset:2304
  v_mfma_f32_32x32x16_bf16 v[80:95], v[108:111], a[12:15], v[80:95]
  ds_read_b64_tr_b16 a[124:125], v247 offset:2048
  ds_read_b64_tr_b16 a[126:127], v247 offset:2304
  v_mfma_f32_32x32x16_bf16 v[64:79], v[108:111], a[16:19], v[64:79]
  ds_read_b64_tr_b16 a[128:129], v246 offset:4096
  ds_read_b64_tr_b16 a[130:131], v246 offset:4352
  v_mfma_f32_32x32x16_bf16 v[80:95], v[108:111], a[20:23], v[80:95]
  ds_read_b64_tr_b16 a[132:133], v247 offset:4096
  ds_read_b64_tr_b16 a[134:135], v247 offset:4352
  v_mfma_f32_32x32x16_bf16 v[64:79], v[108:111], a[24:27], v[64:79]
  ds_read_b64_tr_b16 a[136:137], v246 offset:6144
  ds_read_b64_tr_b16 a[138:139], v246 offset:6400
  v_mfma_f32_32x32x16_bf16 v[80:95], v[108:111], a[28:31], v[80:95]
  ds_read_b64_tr_b16 a[140:141], v247 offset:6144
  ds_read_b64_tr_b16 a[142:143], v247 offset:6400
  v_mfma_f32_32x32x16_bf16 v[64:79], v[108:111], a[32:35], v[64:79]
  ds_read_b64_tr_b16 a[144:145], v246 offset:8192
  ds_read_b64_tr_b16 a[146:147], v246 offset:8448
  v_mfma_f32_32x32x16_bf16 v[80:95], v[108:111], a[36:39], v[80:95]
  ds_read_b64_tr_b16 a[148:149], v247 offset:8192
  ds_read_b64_tr_b16 a[150:151], v247 offset:8448
  v_mfma_f32_32x32x16_bf16 v[64:79], v[108:111], a[40:43], v[64:79]
  ds_read_b64_tr_b16 a[152:153], v246 offset:10240
  ds_read_b64_tr_b16 a[154:155], v246 offset:10496
  v_mfma_f32_32x32x16_bf16 v[80:95], v[108:111], a[44:47], v[80:95]
  ds_read_b64_tr_b16 a[156:157], v247 offset:10240
  ds_read_b64_tr_b16 a[158:159], v247 offset:10496
  v_mfma_f32_32x32x16_bf16 v[64:79], v[108:111], a[48:51], v[64:79]
  ds_read_b64_tr_b16 a[160:161], v246 offset:12288
  ds_read_b64_tr_b16 a[162:163], v246 offset:12544
  v_mfma_f32_32x32x16_bf16 v[80:95], v[108:111], a[52:55], v[80:95]
  ds_read_b64_tr_b16 a[164:165], v247 offset:12288
  ds_read_b64_tr_b16 a[166:167], v247 offset:12544
  v_mfma_f32_32x32x16_bf16 v[64:79], v[108:111], a[56:59], v[64:79]
  ds_read_b64_tr_b16 a[168:169], v246 offset:14336
  ds_read_b64_tr_b16 a[170:171], v246 offset:14592
  v_mfma_f32_32x32x16_bf16 v[80:95], v[108:111], a[60:63], v[80:95]
  ds_read_b64_tr_b16 a[172:173], v247 offset:14336
  ds_read_b64_tr_b16 a[174:175], v247 offset:14592
  v_mfma_f32_32x32x16_bf16 v[64:79], v[108:111], a[64:67], v[64:79]
  ds_read_b64_tr_b16 a[176:177], v246 offset:16384
  ds_read_b64_tr_b16 a[178:179], v246 offset:16640
  v_mfma_f32_32x32x16_bf16 v[80:95], v[108:111], a[68:71], v[80:95]
  ds_read_b64_tr_b16 a[180:181], v247 offset:16384
  ds_read_b64_tr_b16 a[182:183], v247 offset:16640
  v_mfma_f32_32x32x16_bf16 v[64:79], v[108:111], a[72:75], v[64:79]
  ds_read_b64_tr_b16 a[184:185], v246 offset:18432
  ds_read_b64_tr_b16 a[186:187], v246 offset:18688
  v_mfma_f32_32x32x16_bf16 v[80:95], v[108:111], a[76:79], v[80:95]
  ds_read_b64_tr_b16 a[188:189], v247 offset:18432
  ds_read_b64_tr_b16 a[190:191], v247 offset:18688
  v_mfma_f32_32x32x16_bf16 v[64:79], v[108:111], a[80:83], v[64:79]
  ds_read_b64_tr_b16 a[192:193], v246 offset:20480
  ds_read_b64_tr_b16 a[194:195], v246 offset:20736
  v_mfma_f32_32x32x16_bf16 v[80:95], v[108:111], a[84:87], v[80:95]
  ds_read_b64_tr_b16 a[196:197], v247 offset:20480
  ds_read_b64_tr_b16 a[198:199], v247 offset:20736
  v_mfma_f32_32x32x16_bf16 v[64:79], v[108:111], a[88:91], v[64:79]
  ds_read_b64_tr_b16 a[200:201], v246 offset:22528
  ds_read_b64_tr_b16 a[202:203], v246 offset:22784
  v_mfma_f32_32x32x16_bf16 v[80:95], v[108:111], a[92:95], v[80:95]
  ds_read_b64_tr_b16 a[204:205], v247 offset:22528
  ds_read_b64_tr_b16 a[206:207], v247 offset:22784
  v_mfma_f32_32x32x16_bf16 v[64:79], v[108:111], a[96:99], v[64:79]
  ds_read_b64_tr_b16 a[208:209], v246 offset:24576
  ds_read_b64_tr_b16 a[210:211], v246 offset:24832
  v_mfma_f32_32x32x16_bf16 v[80:95], v[108:111], a[100:103], v[80:95]
  ds_read_b64_tr_b16 a[212:213], v247 offset:24576
  ds_read_b64_tr_b16 a[214:215], v247 offset:24832
  v_mfma_f32_32x32x16_bf16 v[64:79], v[108:111], a[104:107], v[64:79]
  ds_read_b64_tr_b16 a[216:217], v246 offset:26624
  ds_read_b64_tr_b16 a[218:219], v246 offset:26880
  v_mfma_f32_32x32x16_bf16 v[80:95], v[108:111], a[108:111], v[80:95]
  ds_read_b64_tr_b16 a[220:221], v247 offset:26624
  ds_read_b64_tr_b16 a[222:223], v247 offset:26880
  v_lshlrev_b32 v4, 4, v1
  s_lshl_b32 s72, s87, 2
  s_mul_i32 s98, s3, 7168
  v_add_u32 v122, s98, v4
  s_mul_i32 s86, s72, 28672
  s_add_u32 s86, s86, s98
  s_add_u32 s86, s86, 4194304
  s_waitcnt lgkmcnt(0)
  s_barrier
  s_add_u32 m0, s98, 0
  s_add_u32 s80, s86, 0
  buffer_load_dwordx4 v4, s[4:7], s80 offen offset:0 sc1 lds
  buffer_load_dwordx4 v4, s[4:7], s80 offen offset:1024 sc1 lds
  buffer_load_dwordx4 v4, s[4:7], s80 offen offset:2048 sc1 lds
  buffer_load_dwordx4 v4, s[4:7], s80 offen offset:3072 sc1 lds
  s_add_u32 m0, s98, 4096
  s_add_u32 s80, s86, 4096
  buffer_load_dwordx4 v4, s[4:7], s80 offen offset:0 sc1 lds
  buffer_load_dwordx4 v4, s[4:7], s80 offen offset:1024 sc1 lds
  buffer_load_dwordx4 v4, s[4:7], s80 offen offset:2048 sc1 lds
  v_mfma_f32_32x32x16_bf16 v[64:79], v[108:111], a[112:115], v[64:79]
  v_lshrrev_b32 v7, 5, v1
  v_bfe_u32 v28, v1, 2, 2
  v_lshl_add_u32 v7, v7, 3, v28
  v_lshlrev_b32 v2, 6, v7
  v_bfe_u32 v7, v1, 4, 1
  v_mfma_f32_32x32x16_bf16 v[80:95], v[108:111], a[116:119], v[80:95]
  v_lshl_add_u32 v2, v7, 5, v2
  v_and_b32 v7, 3, v1
  v_lshl_add_u32 v2, v7, 3, v2
  v_bfe_u32 v7, v1, 4, 1
  v_mul_u32_u24 v5, 57344, v7
  v_mfma_f32_32x32x16_bf16 v[64:79], v[108:111], a[120:123], v[64:79]
  v_lshrrev_b32 v7, 5, v1
  v_lshl_add_u32 v5, v7, 8, v5
  v_and_b32 v7, 15, v1
  v_lshl_add_u32 v5, v7, 4, v5
  v_and_b32 v7, 31, v1
  v_mfma_f32_32x32x16_bf16 v[80:95], v[108:111], a[124:127], v[80:95]
  s_lshl_b32 s76, s87, 9
  s_add_u32 s76, s76, 14712832
  v_lshl_add_u32 v6, v7, 2, s76
  v_lshrrev_b32 v7, 3, v1
  v_mul_u32_u24 v116, 896, v7
  v_mfma_f32_32x32x16_bf16 v[64:79], v[108:111], a[128:131], v[64:79]
  v_lshrrev_b32 v7, 1, v7
  v_lshlrev_b32 v7, 1, v7
  v_and_b32 v28, 7, v1
  v_xor_b32 v28, v28, v7
  v_lshl_add_u32 v116, v28, 4, v116
  v_mfma_f32_32x32x16_bf16 v[80:95], v[108:111], a[132:135], v[80:95]
  v_add_u32 v117, 6144, v116
  v_add_u32 v118, 12288, v116
  v_add_u32 v119, 18432, v116
  v_lshrrev_b32 v7, 5, v1
  v_bfe_u32 v28, v1, 4, 1
  v_mfma_f32_32x32x16_bf16 v[64:79], v[108:111], a[136:139], v[64:79]
  v_lshlrev_b32 v7, 4, v7
  v_lshl_add_u32 v7, v28, 2, v7
  v_bfe_u32 v29, v1, 2, 2
  v_add_u32 v7, v7, v29
  v_lshlrev_b32 v7, 7, v7
  v_mfma_f32_32x32x16_bf16 v[80:95], v[108:111], a[140:143], v[80:95]
  v_lshrrev_b32 v29, 1, v29
  v_lshl_add_u32 v28, v28, 1, v29
  v_and_b32 v29, 3, v1
  v_lshl_add_u32 v7, v29, 3, v7
  s_lshl_b32 s76, s3, 14
  v_mfma_f32_32x32x16_bf16 v[64:79], v[108:111], a[144:147], v[64:79]
  s_add_u32 s76, s76, 86016
  v_add_u32 v7, s76, v7
  v_xor_b32 v29, 0, v28
  v_lshl_add_u32 v8, v29, 5, v7
  v_xor_b32 v29, 1, v28
  v_mfma_f32_32x32x16_bf16 v[80:95], v[108:111], a[148:151], v[80:95]
  v_lshl_add_u32 v9, v29, 5, v7
  v_xor_b32 v29, 2, v28
  v_lshl_add_u32 v10, v29, 5, v7
  v_xor_b32 v29, 3, v28
  v_lshl_add_u32 v11, v29, 5, v7
  v_mfma_f32_32x32x16_bf16 v[64:79], v[108:111], a[152:155], v[64:79]
  s_lshl_b32 s76, s89, 1
  s_add_u32 s76, s76, s90
  s_and_b32 s76, s76, 3
  s_lshl_b32 s76, s76, 1
  s_add_u32 s76, s76, s91
  v_mfma_f32_32x32x16_bf16 v[80:95], v[108:111], a[156:159], v[80:95]
  s_lshl_b32 s76, s76, 1
  s_cmp_ge_u32 s76, 14
  s_cselect_b32 s77, 14, 0
  s_sub_u32 s76, s76, s77
  s_lshl_b32 s58, s76, 10
  v_mfma_f32_32x32x16_bf16 v[64:79], v[108:111], a[160:163], v[64:79]
  s_add_u32 s76, s76, 1
  s_cmp_eq_u32 s76, 14
  s_cselect_b32 s76, 0, s76
  s_lshl_b32 s59, s76, 10
  s_add_u32 s76, s76, 1
  v_mfma_f32_32x32x16_bf16 v[80:95], v[108:111], a[164:167], v[80:95]
  s_cmp_eq_u32 s76, 14
  s_cselect_b32 s76, 0, s76
  s_lshl_b32 s60, s76, 10
  s_add_u32 s76, s76, 1
  s_cmp_eq_u32 s76, 14
  v_mfma_f32_32x32x16_bf16 v[64:79], v[108:111], a[168:171], v[64:79]
  s_cselect_b32 s76, 0, s76
  s_lshl_b32 s61, s76, 10
  s_add_u32 s76, s76, 1
  s_cmp_eq_u32 s76, 14
  s_cselect_b32 s76, 0, s76
  v_mfma_f32_32x32x16_bf16 v[80:95], v[108:111], a[172:175], v[80:95]
  s_lshl_b32 s62, s76, 10
  s_add_u32 s76, s76, 1
  s_cmp_eq_u32 s76, 14
  s_cselect_b32 s76, 0, s76
  s_lshl_b32 s63, s76, 10
  v_mfma_f32_32x32x16_bf16 v[64:79], v[108:111], a[176:179], v[64:79]
  s_add_u32 s76, s76, 1
  s_cmp_eq_u32 s76, 14
  s_cselect_b32 s76, 0, s76
  s_lshl_b32 s64, s76, 10
  s_add_u32 s76, s76, 1
  v_mfma_f32_32x32x16_bf16 v[80:95], v[108:111], a[180:183], v[80:95]
  s_cmp_eq_u32 s76, 14
  s_cselect_b32 s76, 0, s76
  s_lshl_b32 s65, s76, 10
  s_add_u32 s76, s76, 1
  s_cmp_eq_u32 s76, 14
  v_mfma_f32_32x32x16_bf16 v[64:79], v[108:111], a[184:187], v[64:79]
  s_cselect_b32 s76, 0, s76
  s_lshl_b32 s66, s76, 10
  s_add_u32 s76, s76, 1
  s_cmp_eq_u32 s76, 14
  s_cselect_b32 s76, 0, s76
  v_mfma_f32_32x32x16_bf16 v[80:95], v[108:111], a[188:191], v[80:95]
  s_lshl_b32 s67, s76, 10
  s_add_u32 s76, s76, 1
  s_cmp_eq_u32 s76, 14
  s_cselect_b32 s76, 0, s76
  s_lshl_b32 s68, s76, 10
  v_mfma_f32_32x32x16_bf16 v[64:79], v[108:111], a[192:195], v[64:79]
  s_add_u32 s76, s76, 1
  s_cmp_eq_u32 s76, 14
  s_cselect_b32 s76, 0, s76
  s_lshl_b32 s69, s76, 10
  s_add_u32 s76, s76, 1
  v_mfma_f32_32x32x16_bf16 v[80:95], v[108:111], a[196:199], v[80:95]
  s_cmp_eq_u32 s76, 14
  s_cselect_b32 s76, 0, s76
  s_lshl_b32 s70, s76, 10
  s_add_u32 s76, s76, 1
  s_cmp_eq_u32 s76, 14
  v_mfma_f32_32x32x16_bf16 v[64:79], v[108:111], a[200:203], v[64:79]
  s_cselect_b32 s76, 0, s76
  s_lshl_b32 s71, s76, 10
  s_mul_i32 s84, s3, 401408
  s_lshl_b32 s76, s91, 7
  s_add_u32 s84, s84, s76
  v_mfma_f32_32x32x16_bf16 v[80:95], v[108:111], a[204:207], v[80:95]
  s_lshl_b32 s85, s3, 14
  s_add_u32 s85, s85, 86016
  s_mul_i32 s99, s72, 114688
  s_lshl_b32 s76, s88, 2
  s_add_u32 s76, s76, s3
  v_mfma_f32_32x32x16_bf16 v[64:79], v[108:111], a[208:211], v[64:79]
  s_lshl_b32 s76, s76, 10
  s_add_u32 s99, s99, s76
  s_add_u32 s99, s99, 6291456
  s_lshl_b32 s50, s89, 3
  s_add_u32 s50, s50, s90
  v_mfma_f32_32x32x16_bf16 v[80:95], v[108:111], a[212:215], v[80:95]
  s_mul_i32 s50, s50, 57344
  s_mul_i32 s76, s3, 14336
  s_add_u32 s50, s50, s76
  s_add_u32 s50, s50, 6291456
  s_mov_b32 s94, -1
  v_mfma_f32_32x32x16_bf16 v[64:79], v[108:111], a[216:219], v[64:79]
  s_mov_b32 s95, 0
  v_mov_b32 v18, 0
  v_mov_b32 v19, 0
  v_add_u32 v3, 57344, v2
  s_and_b32 s76, s2, 7
  v_mfma_f32_32x32x16_bf16 v[80:95], v[108:111], a[220:223], v[80:95]
  s_lshl_b32 s76, s76, 8
  s_add_u32 s76, s76, 14761984
  v_mov_b32 v126, s76
  s_waitcnt vmcnt(0)
  ds_read_b128 v[128:131], v122 offset:0
  ds_read_b128 v[132:135], v122 offset:1024
  ds_read_b128 v[136:139], v122 offset:2048
  ds_read_b128 v[140:143], v122 offset:3072
  ds_read_b128 v[144:147], v122 offset:4096
  ds_read_b128 v[148:151], v122 offset:5120
  ds_read_b128 v[152:155], v122 offset:6144
  s_waitcnt lgkmcnt(0)
  v_max3_u32 v128, v128, v129, v130
  v_max3_u32 v128, v128, v131, v132
  v_max3_u32 v128, v128, v133, v134
  v_max3_u32 v128, v128, v135, v136
  v_max3_u32 v128, v128, v137, v138
  v_max3_u32 v128, v128, v139, v140
  v_max3_u32 v128, v128, v141, v142
  v_max3_u32 v128, v128, v143, v144
  v_max3_u32 v128, v128, v145, v146
  v_max3_u32 v128, v128, v147, v148
  v_max3_u32 v128, v128, v149, v150
  v_max3_u32 v128, v128, v151, v152
  v_max3_u32 v128, v128, v153, v154
  v_max_u32 v128, v128, v155
  v_cmp_eq_u32 vcc, -1, v128
  s_nop 4
  s_cbranch_vccnz L_mk_20
L_mkb_21:
  s_barrier
  ds_read_b64_tr_b16 v[96:97], v2 offset:0
  ds_read_b64_tr_b16 v[98:99], v2 offset:256
  ds_read_b64_tr_b16 v[100:101], v2 offset:1024
  ds_read_b64_tr_b16 v[102:103], v2 offset:1280
  s_waitcnt lgkmcnt(2)
  v_mfma_f32_32x32x16_bf16 v[32:47], a[0:3], v[96:99], 0
  ds_read_b64_tr_b16 v[104:105], v2 offset:2048
  ds_read_b64_tr_b16 v[106:107], v2 offset:2304
  v_mfma_f32_32x32x16_bf16 v[48:63], a[4:7], v[96:99], 0
  s_add_u32 m0, s98, 28672
  s_add_u32 s80, s86, 28672
  buffer_load_dwordx4 v4, s[4:7], s80 offen offset:0 sc1 lds
  s_waitcnt lgkmcnt(2)
  v_mfma_f32_32x32x16_bf16 v[32:47], a[8:11], v[100:103], v[32:47]
  ds_read_b64_tr_b16 v[96:97], v2 offset:3072
  ds_read_b64_tr_b16 v[98:99], v2 offset:3328
  v_cvt_pk_bf16_f32 v7, v64, v64
  v_lshlrev_b32 v7, 16, v7
  v_sub_f32 v28, v64, v7
  v_cvt_pk_bf16_f32 v20, v64, v28
  v_mfma_f32_32x32x16_bf16 v[48:63], a[12:15], v[100:103], v[48:63]
  buffer_load_dwordx4 v4, s[4:7], s80 offen offset:1024 sc1 lds
  v_and_b32 v7, 0xffff0000, v20
  v_sub_f32 v28, v28, v7
  v_cvt_pk_bf16_f32 v21, v28, 0
  v_cndmask_b32 v20, 0, v20, s[94:95]
  s_waitcnt lgkmcnt(2)
  v_mfma_f32_32x32x16_bf16 v[32:47], a[16:19], v[104:107], v[32:47]
  ds_read_b64_tr_b16 v[100:101], v2 offset:4096
  ds_read_b64_tr_b16 v[102:103], v2 offset:4352
  v_cndmask_b32 v21, 0, v21, s[94:95]
  v_mov_b32 v22, 0
  v_mov_b32 v23, 0
  v_cvt_pk_bf16_f32 v7, v80, v80
  v_mfma_f32_32x32x16_bf16 v[48:63], a[20:23], v[104:107], v[48:63]
  buffer_load_dwordx4 v4, s[4:7], s80 offen offset:2048 sc1 lds
  v_lshlrev_b32 v7, 16, v7
  v_sub_f32 v28, v80, v7
  v_cvt_pk_bf16_f32 v24, v80, v28
  v_and_b32 v7, 0xffff0000, v24
  s_waitcnt lgkmcnt(2)
  v_mfma_f32_32x32x16_bf16 v[32:47], a[24:27], v[96:99], v[32:47]
  ds_read_b64_tr_b16 v[104:105], v2 offset:5120
  ds_read_b64_tr_b16 v[106:107], v2 offset:5376
  v_sub_f32 v28, v28, v7
  v_cvt_pk_bf16_f32 v25, v28, 0
  v_cndmask_b32 v24, 0, v24, s[94:95]
  v_cndmask_b32 v25, 0, v25, s[94:95]
  v_mfma_f32_32x32x16_bf16 v[48:63], a[28:31], v[96:99], v[48:63]
  buffer_load_dwordx4 v4, s[4:7], s80 offen offset:3072 sc1 lds
  v_mov_b32 v26, 0
  v_mov_b32 v27, 0
  s_waitcnt lgkmcnt(2)
  v_mfma_f32_32x32x16_bf16 v[32:47], a[32:35], v[100:103], v[32:47]
  ds_read_b64_tr_b16 v[96:97], v2 offset:6144
  ds_read_b64_tr_b16 v[98:99], v2 offset:6400
  v_mfma_f32_32x32x16_bf16 v[48:63], a[36:39], v[100:103], v[48:63]
  s_add_u32 m0, s98, 32768
  s_add_u32 s80, s86, 32768
  buffer_load_dwordx4 v4, s[4:7], s80 offen offset:0 sc1 lds
  s_waitcnt lgkmcnt(2)
  v_mfma_f32_32x32x16_bf16 v[32:47], a[40:43], v[104:107], v[32:47]
  ds_read_b64_tr_b16 v[100:101], v2 offset:7168
  ds_read_b64_tr_b16 v[102:103], v2 offset:7424
  v_mfma_f32_32x32x16_bf16 v[48:63], a[44:47], v[104:107], v[48:63]
  buffer_load_dwordx4 v4, s[4:7], s80 offen offset:1024 sc1 lds
  s_waitcnt lgkmcnt(2)
  v_mfma_f32_32x32x16_bf16 v[32:47], a[48:51], v[96:99], v[32:47]
  ds_read_b64_tr_b16 v[104:105], v2 offset:8192
  ds_read_b64_tr_b16 v[106:107], v2 offset:8448
  v_mfma_f32_32x32x16_bf16 v[48:63], a[52:55], v[96:99], v[48:63]
  buffer_load_dwordx4 v4, s[4:7], s80 offen offset:2048 sc1 lds
  s_waitcnt lgkmcnt(2)
  v_mfma_f32_32x32x16_bf16 v[32:47], a[56:59], v[100:103], v[32:47]
  ds_read_b64_tr_b16 v[96:97], v2 offset:9216
  ds_read_b64_tr_b16 v[98:99], v2 offset:9472
  v_mfma_f32_32x32x16_bf16 v[48:63], a[60:63], v[100:103], v[48:63]
  s_add_u32 m0, s85, 0
  s_mul_i32 s53, s58, 28
  s_add_u32 s53, s53, s84
  buffer_load_dwordx4 v116, s[36:39], s53 offen offset:0 lds
  s_waitcnt lgkmcnt(2)
  v_mfma_f32_32x32x16_bf16 v[32:47], a[64:67], v[104:107], v[32:47]
  ds_read_b64_tr_b16 v[100:101], v2 offset:10240
  ds_read_b64_tr_b16 v[102:103], v2 offset:10496
  v_mfma_f32_32x32x16_bf16 v[48:63], a[68:71], v[104:107], v[48:63]
  buffer_load_dwordx4 v117, s[36:39], s53 offen offset:1024 lds
  s_waitcnt lgkmcnt(2)
  v_mfma_f32_32x32x16_bf16 v[32:47], a[72:75], v[96:99], v[32:47]
  ds_read_b64_tr_b16 v[104:105], v2 offset:11264
  ds_read_b64_tr_b16 v[106:107], v2 offset:11520
  v_mfma_f32_32x32x16_bf16 v[48:63], a[76:79], v[96:99], v[48:63]
  buffer_load_dwordx4 v118, s[36:39], s53 offen offset:2048 lds
  s_waitcnt lgkmcnt(2)
  v_mfma_f32_32x32x16_bf16 v[32:47], a[80:83], v[100:103], v[32:47]
  ds_read_b64_tr_b16 v[96:97], v2 offset:12288
  ds_read_b64_tr_b16 v[98:99], v2 offset:12544
  v_mfma_f32_32x32x16_bf16 v[48:63], a[84:87], v[100:103], v[48:63]
  buffer_load_dwordx4 v119, s[36:39], s53 offen offset:3072 lds
  s_waitcnt lgkmcnt(2)
  v_mfma_f32_32x32x16_bf16 v[32:47], a[88:91], v[104:107], v[32:47]
  ds_read_b64_tr_b16 v[100:101], v2 offset:13312
  ds_read_b64_tr_b16 v[102:103], v2 offset:13568
  v_mfma_f32_32x32x16_bf16 v[48:63], a[92:95], v[104:107], v[48:63]
  s_add_u32 m0, s85, 4096
  s_mul_i32 s53, s59, 28
  s_add_u32 s53, s53, s84
  buffer_load_dwordx4 v116, s[36:39], s53 offen offset:0 lds
  s_waitcnt lgkmcnt(2)
  v_mfma_f32_32x32x16_bf16 v[32:47], a[96:99], v[96:99], v[32:47]
  ds_read_b64_tr_b16 v[104:105], v2 offset:14336
  ds_read_b64_tr_b16 v[106:107], v2 offset:14592
  v_mfma_f32_32x32x16_bf16 v[48:63], a[100:103], v[96:99], v[48:63]
  buffer_load_dwordx4 v117, s[36:39], s53 offen offset:1024 lds
  s_waitcnt lgkmcnt(2)
  v_mfma_f32_32x32x16_bf16 v[32:47], a[104:107], v[100:103], v[32:47]
  ds_read_b64_tr_b16 v[96:97], v2 offset:15360
  ds_read_b64_tr_b16 v[98:99], v2 offset:15616
  v_mfma_f32_32x32x16_bf16 v[48:63], a[108:111], v[100:103], v[48:63]
  buffer_load_dwordx4 v118, s[36:39], s53 offen offset:2048 lds
  s_waitcnt lgkmcnt(2)
  v_mfma_f32_32x32x16_bf16 v[32:47], a[112:115], v[104:107], v[32:47]
  ds_read_b64_tr_b16 v[100:101], v2 offset:16384
  ds_read_b64_tr_b16 v[102:103], v2 offset:16640
  v_mfma_f32_32x32x16_bf16 v[48:63], a[116:119], v[104:107], v[48:63]
  buffer_load_dwordx4 v119, s[36:39], s53 offen offset:3072 lds
  s_waitcnt lgkmcnt(2)
  v_mfma_f32_32x32x16_bf16 v[32:47], a[120:123], v[96:99], v[32:47]
  ds_read_b64_tr_b16 v[104:105], v2 offset:17408
  ds_read_b64_tr_b16 v[106:107], v2 offset:17664
  v_mfma_f32_32x32x16_bf16 v[48:63], a[124:127], v[96:99], v[48:63]
  s_add_u32 m0, s85, 8192
  s_mul_i32 s53, s60, 28
  s_add_u32 s53, s53, s84
  buffer_load_dwordx4 v116, s[36:39], s53 offen offset:0 lds
  s_waitcnt vmcnt(9)
  ds_read_b128 v[128:131], v122 offset:28672
  ds_read_b128 v[132:135], v122 offset:29696
  s_waitcnt lgkmcnt(4)
  v_mfma_f32_32x32x16_bf16 v[32:47], a[128:131], v[100:103], v[32:47]
  ds_read_b64_tr_b16 v[96:97], v2 offset:18432
  ds_read_b64_tr_b16 v[98:99], v2 offset:18688
  v_mfma_f32_32x32x16_bf16 v[48:63], a[132:135], v[100:103], v[48:63]
  buffer_load_dwordx4 v117, s[36:39], s53 offen offset:1024 lds
  ds_read_b128 v[136:139], v122 offset:30720
  ds_read_b128 v[140:143], v122 offset:31744
  s_waitcnt lgkmcnt(6)
  v_mfma_f32_32x32x16_bf16 v[32:47], a[136:139], v[104:107], v[32:47]
  ds_read_b64_tr_b16 v[100:101], v2 offset:19456
  ds_read_b64_tr_b16 v[102:103], v2 offset:19712
  v_mfma_f32_32x32x16_bf16 v[48:63], a[140:143], v[104:107], v[48:63]
  buffer_load_dwordx4 v118, s[36:39], s53 offen offset:2048 lds
  ds_read_b128 v[144:147], v122 offset:32768
  ds_read_b128 v[148:151], v122 offset:33792
  s_waitcnt lgkmcnt(6)
  v_mfma_f32_32x32x16_bf16 v[32:47], a[144:147], v[96:99], v[32:47]
  ds_read_b64_tr_b16 v[104:105], v2 offset:20480
  ds_read_b64_tr_b16 v[106:107], v2 offset:20736
  v_mfma_f32_32x32x16_bf16 v[48:63], a[148:151], v[96:99], v[48:63]
  buffer_load_dwordx4 v119, s[36:39], s53 offen offset:3072 lds
  ds_read_b128 v[152:155], v122 offset:34816
  s_waitcnt lgkmcnt(5)
  v_mfma_f32_32x32x16_bf16 v[32:47], a[152:155], v[100:103], v[32:47]
  ds_read_b64_tr_b16 v[96:97], v2 offset:21504
  ds_read_b64_tr_b16 v[98:99], v2 offset:21760
  v_mfma_f32_32x32x16_bf16 v[48:63], a[156:159], v[100:103], v[48:63]
  s_add_u32 m0, s98, 57344
  s_add_u32 s80, s86, 57344
  buffer_load_dwordx4 v4, s[4:7], s80 offen offset:0 sc1 lds
  s_waitcnt lgkmcnt(3)
  v_mfma_f32_32x32x16_bf16 v[32:47], a[160:163], v[104:107], v[32:47]
  ds_read_b64_tr_b16 v[100:101], v2 offset:22528
  ds_read_b64_tr_b16 v[102:103], v2 offset:22784
  v_mfma_f32_32x32x16_bf16 v[48:63], a[164:167], v[104:107], v[48:63]
  buffer_load_dwordx4 v4, s[4:7], s80 offen offset:1024 sc1 lds
  s_waitcnt lgkmcnt(4)
  v_max3_u32 v128, v128, v129, v130
  v_max3_u32 v128, v128, v131, v132
  v_max3_u32 v128, v128, v133, v134
  v_max3_u32 v128, v128, v135, v136
  s_waitcnt lgkmcnt(2)
  v_mfma_f32_32x32x16_bf16 v[32:47], a[168:171], v[96:99], v[32:47]
  ds_read_b64_tr_b16 v[104:105], v2 offset:23552
  ds_read_b64_tr_b16 v[106:107], v2 offset:23808
  v_mfma_f32_32x32x16_bf16 v[48:63], a[172:175], v[96:99], v[48:63]
  buffer_load_dwordx4 v4, s[4:7], s80 offen offset:2048 sc1 lds
  v_max3_u32 v128, v128, v137, v138
  v_max3_u32 v128, v128, v139, v140
  v_max3_u32 v128, v128, v141, v142
  v_max3_u32 v128, v128, v143, v144
  buffer_load_dword v13, v6, s[4:7], 0 offen offset:0 sc1
  s_waitcnt lgkmcnt(2)
  v_mfma_f32_32x32x16_bf16 v[32:47], a[176:179], v[100:103], v[32:47]
  ds_read_b64_tr_b16 v[96:97], v2 offset:24576
  ds_read_b64_tr_b16 v[98:99], v2 offset:24832
  v_mfma_f32_32x32x16_bf16 v[48:63], a[180:183], v[100:103], v[48:63]
  buffer_load_dwordx4 v4, s[4:7], s80 offen offset:3072 sc1 lds
  v_max3_u32 v128, v128, v145, v146
  v_max3_u32 v128, v128, v147, v148
  v_max3_u32 v128, v128, v149, v150
  v_max3_u32 v128, v128, v151, v152
  s_waitcnt lgkmcnt(2)
  v_mfma_f32_32x32x16_bf16 v[32:47], a[184:187], v[104:107], v[32:47]
  ds_read_b64_tr_b16 v[100:101], v2 offset:25600
  ds_read_b64_tr_b16 v[102:103], v2 offset:25856
  v_mfma_f32_32x32x16_bf16 v[48:63], a[188:191], v[104:107], v[48:63]
  s_add_u32 m0, s98, 61440
  s_add_u32 s80, s86, 61440
  buffer_load_dwordx4 v4, s[4:7], s80 offen offset:0 sc1 lds
  v_max3_u32 v128, v128, v153, v154
  v_max_u32 v128, v128, v155
  s_waitcnt lgkmcnt(2)
  v_mfma_f32_32x32x16_bf16 v[32:47], a[192:195], v[96:99], v[32:47]
  ds_read_b64_tr_b16 v[104:105], v2 offset:26624
  ds_read_b64_tr_b16 v[106:107], v2 offset:26880
  v_mfma_f32_32x32x16_bf16 v[48:63], a[196:199], v[96:99], v[48:63]
  buffer_load_dwordx4 v4, s[4:7], s80 offen offset:1024 sc1 lds
  s_waitcnt lgkmcnt(2)
  v_mfma_f32_32x32x16_bf16 v[32:47], a[200:203], v[100:103], v[32:47]
  ds_read_b64_tr_b16 v[96:97], v2 offset:27648
  ds_read_b64_tr_b16 v[98:99], v2 offset:27904
  v_mfma_f32_32x32x16_bf16 v[48:63], a[204:207], v[100:103], v[48:63]
  buffer_load_dwordx4 v4, s[4:7], s80 offen offset:2048 sc1 lds
  v_cmp_eq_u32 vcc, -1, v128
  s_nop 4
  s_cbranch_vccnz L_mk_22
L_mkb_23:
  s_barrier
  s_waitcnt lgkmcnt(2)
  v_mfma_f32_32x32x16_bf16 v[32:47], a[208:211], v[104:107], v[32:47]
  ds_read_b64_tr_b16 v[100:101], v2 offset:28672
  ds_read_b64_tr_b16 v[102:103], v2 offset:28928
  v_mfma_f32_32x32x16_bf16 v[48:63], a[212:215], v[104:107], v[48:63]
  s_add_u32 m0, s85, 12288
  s_mul_i32 s53, s61, 28
  s_add_u32 s53, s53, s84
  buffer_load_dwordx4 v116, s[36:39], s53 offen offset:0 lds
  s_waitcnt lgkmcnt(2)
  v_mfma_f32_32x32x16_bf16 v[32:47], a[216:219], v[96:99], v[32:47]
  ds_read_b64_tr_b16 v[104:105], v2 offset:29696
  ds_read_b64_tr_b16 v[106:107], v2 offset:29952
  v_mfma_f32_32x32x16_bf16 v[48:63], a[220:223], v[96:99], v[48:63]
  buffer_load_dwordx4 v117, s[36:39], s53 offen offset:1024 lds
  s_waitcnt lgkmcnt(2)
  v_mfma_f32_32x32x16_bf16 v[64:79], a[0:3], v[100:103], 0
  ds_read_b64_tr_b16 v[96:97], v2 offset:30720
  ds_read_b64_tr_b16 v[98:99], v2 offset:30976
  s_waitcnt vmcnt(6)
  s_mov_b32 s92, 40000
L_stl_24:
  v_cmp_eq_u32 vcc, 0, v13
  s_nop 4
  s_cbranch_vccz L_sto_25
  buffer_load_dword v13, v6, s[4:7], 0 offen offset:0 sc1
  s_waitcnt vmcnt(0)
  s_sub_u32 s92, s92, 1
  s_cmp_lg_u32 s92, 0
  s_cbranch_scc1 L_stl_24
L_sto_25:
  v_mfma_f32_32x32x16_bf16 v[80:95], a[4:7], v[100:103], 0
  buffer_load_dwordx4 v118, s[36:39], s53 offen offset:2048 lds
  v_and_b32 v14, 0xffff0000, v13
  v_and_b32 v17, 0xffff, v13
  v_rcp_f32 v15, v14
  s_waitcnt lgkmcnt(2)
  v_mfma_f32_32x32x16_bf16 v[64:79], a[8:11], v[104:107], v[64:79]
  ds_read_b64_tr_b16 v[100:101], v2 offset:31744
  ds_read_b64_tr_b16 v[102:103], v2 offset:32000
  v_xor_b32 v17, 0x8000, v17
  v_cndmask_b32 v17, 0, v17, s[94:95]
  v_lshl_or_b32 v16, v17, 16, v17
  v_mul_f32 v15, 0xbfb8aa3b, v15
  v_mfma_f32_32x32x16_bf16 v[80:95], a[12:15], v[104:107], v[80:95]
  buffer_load_dwordx4 v119, s[36:39], s53 offen offset:3072 lds
  s_nop 0
  v_mfma_f32_32x32x16_bf16 v[32:47], v[20:23], v[16:19], v[32:47]
  v_mfma_f32_32x32x16_bf16 v[48:63], v[24:27], v[16:19], v[48:63]
  s_waitcnt lgkmcnt(2)
  v_mfma_f32_32x32x16_bf16 v[64:79], a[16:19], v[96:99], v[64:79]
  ds_read_b64_tr_b16 v[104:105], v2 offset:32768
  ds_read_b64_tr_b16 v[106:107], v2 offset:33024
  v_mfma_f32_32x32x16_bf16 v[80:95], a[20:23], v[96:99], v[80:95]
  ds_read_b64_tr_b16 a[224:225], v8 offset:0
  ds_read_b64_tr_b16 a[226:227], v8 offset:1024
  s_waitcnt lgkmcnt(4)
  v_mfma_f32_32x32x16_bf16 v[64:79], a[24:27], v[100:103], v[64:79]
  ds_read_b64_tr_b16 v[96:97], v2 offset:33792
  ds_read_b64_tr_b16 v[98:99], v2 offset:34048
  v_mfma_f32_32x32x16_bf16 v[80:95], a[28:31], v[100:103], v[80:95]
  ds_read_b64_tr_b16 a[228:229], v9 offset:0
  ds_read_b64_tr_b16 a[230:231], v9 offset:1024
  s_waitcnt lgkmcnt(6)
  v_mfma_f32_32x32x16_bf16 v[64:79], a[32:35], v[104:107], v[64:79]
  ds_read_b64_tr_b16 v[100:101], v2 offset:34816
  ds_read_b64_tr_b16 v[102:103], v2 offset:35072
  v_mul_f32 v32, v32, v15
  v_mul_f32 v33, v33, v15
  v_mul_f32 v34, v34, v15
  v_mul_f32 v35, v35, v15
  v_mfma_f32_32x32x16_bf16 v[80:95], a[36:39], v[104:107], v[80:95]
  ds_read_b64_tr_b16 a[232:233], v10 offset:0
  ds_read_b64_tr_b16 a[234:235], v10 offset:1024
  v_mul_f32 v36, v36, v15
  v_mul_f32 v37, v37, v15
  v_mul_f32 v38, v38, v15
  s_waitcnt lgkmcnt(6)
  v_mfma_f32_32x32x16_bf16 v[64:79], a[40:43], v[96:99], v[64:79]
  ds_read_b64_tr_b16 v[104:105], v2 offset:35840
  ds_read_b64_tr_b16 v[106:107], v2 offset:36096
  v_mul_f32 v39, v39, v15
  v_exp_f32 v32, v32
  v_mfma_f32_32x32x16_bf16 v[80:95], a[44:47], v[96:99], v[80:95]
  ds_read_b64_tr_b16 a[236:237], v11 offset:0
  ds_read_b64_tr_b16 a[238:239], v11 offset:1024
  v_exp_f32 v33, v33
  s_waitcnt lgkmcnt(6)
  v_mfma_f32_32x32x16_bf16 v[64:79], a[48:51], v[100:103], v[64:79]
  ds_read_b64_tr_b16 v[96:97], v2 offset:36864
  ds_read_b64_tr_b16 v[98:99], v2 offset:37120
  v_exp_f32 v34, v34
  v_exp_f32 v35, v35
  v_mfma_f32_32x32x16_bf16 v[80:95], a[52:55], v[100:103], v[80:95]
  ds_read_b64_tr_b16 a[240:241], v8 offset:4096
  ds_read_b64_tr_b16 a[242:243], v8 offset:5120
  v_exp_f32 v36, v36
  s_waitcnt lgkmcnt(6)
  v_mfma_f32_32x32x16_bf16 v[64:79], a[56:59], v[104:107], v[64:79]
  ds_read_b64_tr_b16 v[100:101], v2 offset:37888
  ds_read_b64_tr_b16 v[102:103], v2 offset:38144
  v_exp_f32 v37, v37
  v_exp_f32 v38, v38
  v_mfma_f32_32x32x16_bf16 v[80:95], a[60:63], v[104:107], v[80:95]
  ds_read_b64_tr_b16 a[244:245], v9 offset:4096
  ds_read_b64_tr_b16 a[246:247], v9 offset:5120
  s_waitcnt lgkmcnt(8)
  s_add_u32 m0, s85, 0
  s_mul_i32 s53, s62, 28
  s_add_u32 s53, s53, s84
  buffer_load_dwordx4 v116, s[36:39], s53 offen offset:0 lds
  v_exp_f32 v39, v39
  s_waitcnt lgkmcnt(6)
  v_mfma_f32_32x32x16_bf16 v[64:79], a[64:67], v[96:99], v[64:79]
  ds_read_b64_tr_b16 v[104:105], v2 offset:38912
  ds_read_b64_tr_b16 v[106:107], v2 offset:39168
  v_fma_f32 v32, v32, v14, v14
  v_fma_f32 v33, v33, v14, v14
  v_fma_f32 v34, v34, v14, v14
  v_fma_f32 v35, v35, v14, v14
  v_mfma_f32_32x32x16_bf16 v[80:95], a[68:71], v[96:99], v[80:95]
  ds_read_b64_tr_b16 a[248:249], v10 offset:4096
  ds_read_b64_tr_b16 a[250:251], v10 offset:5120
  buffer_load_dwordx4 v117, s[36:39], s53 offen offset:1024 lds
  v_fma_f32 v36, v36, v14, v14
  v_fma_f32 v37, v37, v14, v14
  buffer_load_dword v125, v126, s[4:7], 0 offen sc1
  s_waitcnt lgkmcnt(6)
  v_mfma_f32_32x32x16_bf16 v[64:79], a[72:75], v[100:103], v[64:79]
  ds_read_b64_tr_b16 v[96:97], v2 offset:39936
  ds_read_b64_tr_b16 v[98:99], v2 offset:40192
  v_fma_f32 v38, v38, v14, v14
  v_fma_f32 v39, v39, v14, v14
  v_rcp_f32 v32, v32
  v_mfma_f32_32x32x16_bf16 v[80:95], a[76:79], v[100:103], v[80:95]
  ds_read_b64_tr_b16 a[252:253], v11 offset:4096
  ds_read_b64_tr_b16 a[254:255], v11 offset:5120
  buffer_load_dwordx4 v118, s[36:39], s53 offen offset:2048 lds
  v_rcp_f32 v33, v33
  s_waitcnt lgkmcnt(6)
  v_mfma_f32_32x32x16_bf16 v[64:79], a[80:83], v[104:107], v[64:79]
  ds_read_b64_tr_b16 v[100:101], v2 offset:40960
  ds_read_b64_tr_b16 v[102:103], v2 offset:41216
  v_rcp_f32 v34, v34
  v_rcp_f32 v35, v35
  v_mfma_f32_32x32x16_bf16 v[80:95], a[84:87], v[104:107], v[80:95]
  ds_read_b64_tr_b16 v[160:161], v8 offset:8192
  ds_read_b64_tr_b16 v[162:163], v8 offset:9216
  buffer_load_dwordx4 v119, s[36:39], s53 offen offset:3072 lds
  v_rcp_f32 v36, v36
  s_waitcnt lgkmcnt(6)
  v_mfma_f32_32x32x16_bf16 v[64:79], a[88:91], v[96:99], v[64:79]
  ds_read_b64_tr_b16 v[104:105], v2 offset:41984
  ds_read_b64_tr_b16 v[106:107], v2 offset:42240
  v_rcp_f32 v37, v37
  v_rcp_f32 v38, v38
  v_mfma_f32_32x32x16_bf16 v[80:95], a[92:95], v[96:99], v[80:95]
  ds_read_b64_tr_b16 v[164:165], v9 offset:8192
  ds_read_b64_tr_b16 v[166:167], v9 offset:9216
  s_waitcnt lgkmcnt(8)
  s_add_u32 m0, s85, 4096
  s_mul_i32 s53, s63, 28
  s_add_u32 s53, s53, s84
  buffer_load_dwordx4 v116, s[36:39], s53 offen offset:0 lds
  v_rcp_f32 v39, v39
  s_waitcnt lgkmcnt(6)
  v_mfma_f32_32x32x16_bf16 v[64:79], a[96:99], v[100:103], v[64:79]
  ds_read_b64_tr_b16 v[96:97], v2 offset:43008
  ds_read_b64_tr_b16 v[98:99], v2 offset:43264
  v_mul_f32 v40, v40, v32
  v_mul_f32 v41, v41, v33
  v_mul_f32 v42, v42, v34
  v_mul_f32 v43, v43, v35
  v_mfma_f32_32x32x16_bf16 v[80:95], a[100:103], v[100:103], v[80:95]
  ds_read_b64_tr_b16 v[168:169], v10 offset:8192
  ds_read_b64_tr_b16 v[170:171], v10 offset:9216
  buffer_load_dwordx4 v117, s[36:39], s53 offen offset:1024 lds
  v_mul_f32 v44, v44, v36
  v_mul_f32 v45, v45, v37
  s_waitcnt lgkmcnt(6)
  v_mfma_f32_32x32x16_bf16 v[64:79], a[104:107], v[104:107], v[64:79]
  ds_read_b64_tr_b16 v[100:101], v2 offset:44032
  ds_read_b64_tr_b16 v[102:103], v2 offset:44288
  v_mul_f32 v46, v46, v38
  v_mul_f32 v47, v47, v39
  v_cvt_pk_bf16_f32 v108, v40, v41
  v_cvt_pk_bf16_f32 v109, v42, v43
  v_mfma_f32_32x32x16_bf16 v[80:95], a[108:111], v[104:107], v[80:95]
  ds_read_b64_tr_b16 v[172:173], v11 offset:8192
  ds_read_b64_tr_b16 v[174:175], v11 offset:9216
  buffer_load_dwordx4 v118, s[36:39], s53 offen offset:2048 lds
  v_cvt_pk_bf16_f32 v110, v44, v45
  v_cvt_pk_bf16_f32 v111, v46, v47
  s_waitcnt lgkmcnt(6)
  v_mfma_f32_32x32x16_bf16 v[64:79], a[112:115], v[96:99], v[64:79]
  ds_read_b64_tr_b16 v[104:105], v2 offset:45056
  ds_read_b64_tr_b16 v[106:107], v2 offset:45312
  v_mul_f32 v48, v48, v15
  v_mul_f32 v49, v49, v15
  v_mul_f32 v50, v50, v15
  v_mul_f32 v51, v51, v15
  v_mfma_f32_32x32x16_bf16 v[80:95], a[116:119], v[96:99], v[80:95]
  s_waitcnt vmcnt(8)
  ds_read_b64_tr_b16 v[176:177], v8 offset:12288
  ds_read_b64_tr_b16 v[178:179], v8 offset:13312
  buffer_load_dwordx4 v119, s[36:39], s53 offen offset:3072 lds
  v_mul_f32 v52, v52, v15
  v_mul_f32 v53, v53, v15
  s_waitcnt lgkmcnt(6)
  v_mfma_f32_32x32x16_bf16 v[64:79], a[120:123], v[100:103], v[64:79]
  ds_read_b64_tr_b16 v[96:97], v2 offset:46080
  ds_read_b64_tr_b16 v[98:99], v2 offset:46336
  v_mul_f32 v54, v54, v15
  v_mul_f32 v55, v55, v15
  v_exp_f32 v48, v48
  v_mfma_f32_32x32x16_bf16 v[80:95], a[124:127], v[100:103], v[80:95]
  ds_read_b64_tr_b16 v[180:181], v9 offset:12288
  ds_read_b64_tr_b16 v[182:183], v9 offset:13312
  s_waitcnt lgkmcnt(8)
  s_add_u32 m0, s85, 8192
  s_mul_i32 s53, s64, 28
  s_add_u32 s53, s53, s84
  buffer_load_dwordx4 v116, s[36:39], s53 offen offset:0 lds
  v_exp_f32 v49, v49
  ds_read_b128 v[128:131], v122 offset:57344
  ds_read_b128 v[132:135], v122 offset:58368
  s_waitcnt lgkmcnt(8)
  v_mfma_f32_32x32x16_bf16 v[64:79], a[128:131], v[104:107], v[64:79]
  ds_read_b64_tr_b16 v[100:101], v2 offset:47104
  ds_read_b64_tr_b16 v[102:103], v2 offset:47360
  v_exp_f32 v50, v50
  v_exp_f32 v51, v51
  v_mfma_f32_32x32x16_bf16 v[80:95], a[132:135], v[104:107], v[80:95]
  ds_read_b64_tr_b16 v[184:185], v10 offset:12288
  ds_read_b64_tr_b16 v[186:187], v10 offset:13312
  buffer_load_dwordx4 v117, s[36:39], s53 offen offset:1024 lds
  v_exp_f32 v52, v52
  ds_read_b128 v[136:139], v122 offset:59392
  ds_read_b128 v[140:143], v122 offset:60416
  s_waitcnt lgkmcnt(10)
  v_mfma_f32_32x32x16_bf16 v[64:79], a[136:139], v[96:99], v[64:79]
  ds_read_b64_tr_b16 v[104:105], v2 offset:48128
  ds_read_b64_tr_b16 v[106:107], v2 offset:48384
  v_exp_f32 v53, v53
  v_exp_f32 v54, v54
  v_mfma_f32_32x32x16_bf16 v[80:95], a[140:143], v[96:99], v[80:95]
  ds_read_b64_tr_b16 v[188:189], v11 offset:12288
  ds_read_b64_tr_b16 v[190:191], v11 offset:13312
  buffer_load_dwordx4 v118, s[36:39], s53 offen offset:2048 lds
  v_exp_f32 v55, v55
  ds_read_b128 v[144:147], v122 offset:61440
  ds_read_b128 v[148:151], v122 offset:62464
  s_waitcnt lgkmcnt(10)
  v_mfma_f32_32x32x16_bf16 v[64:79], a[144:147], v[100:103], v[64:79]
  ds_read_b64_tr_b16 v[96:97], v2 offset:49152
  ds_read_b64_tr_b16 v[98:99], v2 offset:49408
  v_fma_f32 v48, v48, v14, v14
  v_fma_f32 v49, v49, v14, v14
  v_fma_f32 v50, v50, v14, v14
  v_fma_f32 v51, v51, v14, v14
  v_mfma_f32_32x32x16_bf16 v[80:95], a[148:151], v[100:103], v[80:95]
  buffer_load_dwordx4 v119, s[36:39], s53 offen offset:3072 lds
  v_fma_f32 v52, v52, v14, v14
  v_fma_f32 v53, v53, v14, v14
  v_fma_f32 v54, v54, v14, v14
  v_fma_f32 v55, v55, v14, v14
  ds_read_b128 v[152:155], v122 offset:63488
  s_waitcnt lgkmcnt(7)
  v_mfma_f32_32x32x16_bf16 v[64:79], a[152:155], v[104:107], v[64:79]
  ds_read_b64_tr_b16 v[100:101], v2 offset:50176
  ds_read_b64_tr_b16 v[102:103], v2 offset:50432
  v_rcp_f32 v48, v48
  v_rcp_f32 v49, v49
  v_mfma_f32_32x32x16_bf16 v[80:95], a[156:159], v[104:107], v[80:95]
  s_waitcnt lgkmcnt(7)
  s_add_u32 m0, s85, 12288
  s_mul_i32 s53, s65, 28
  s_add_u32 s53, s53, s84
  buffer_load_dwordx4 v116, s[36:39], s53 offen offset:0 lds
  v_rcp_f32 v50, v50
  v_rcp_f32 v51, v51
  s_waitcnt lgkmcnt(3)
  v_mfma_f32_32x32x16_bf16 v[64:79], a[160:163], v[96:99], v[64:79]
  ds_read_b64_tr_b16 v[104:105], v2 offset:51200
  ds_read_b64_tr_b16 v[106:107], v2 offset:51456
  v_rcp_f32 v52, v52
  v_rcp_f32 v53, v53
  v_mfma_f32_32x32x16_bf16 v[80:95], a[164:167], v[96:99], v[80:95]
  buffer_load_dwordx4 v117, s[36:39], s53 offen offset:1024 lds
  v_rcp_f32 v54, v54
  v_rcp_f32 v55, v55
  s_waitcnt lgkmcnt(4)
  v_max3_u32 v128, v128, v129, v130
  v_max3_u32 v128, v128, v131, v132
  v_max3_u32 v128, v128, v133, v134
  v_max3_u32 v128, v128, v135, v136
  s_waitcnt vmcnt(12)
  v_cmp_gt_u32 vcc, 32, v125
  s_nop 4
  s_cbranch_vccnz L_fh_26
L_fhb_27:
  s_waitcnt lgkmcnt(2)
  v_mfma_f32_32x32x16_bf16 v[64:79], a[168:171], v[100:103], v[64:79]
  ds_read_b64_tr_b16 v[96:97], v2 offset:52224
  ds_read_b64_tr_b16 v[98:99], v2 offset:52480
  v_mul_f32 v56, v56, v48
  v_mul_f32 v57, v57, v49
  v_mul_f32 v58, v58, v50
  v_mul_f32 v59, v59, v51
  v_mfma_f32_32x32x16_bf16 v[80:95], a[172:175], v[100:103], v[80:95]
  buffer_load_dwordx4 v118, s[36:39], s53 offen offset:2048 lds
  v_mul_f32 v60, v60, v52
  v_mul_f32 v61, v61, v53
  v_mul_f32 v62, v62, v54
  v_mul_f32 v63, v63, v55
  v_max3_u32 v128, v128, v137, v138
  v_max3_u32 v128, v128, v139, v140
  v_max3_u32 v128, v128, v141, v142
  v_max3_u32 v128, v128, v143, v144
  buffer_load_dword v12, v6, s[4:7], 0 offen offset:128 sc1
  s_waitcnt lgkmcnt(2)
  v_mfma_f32_32x32x16_bf16 v[64:79], a[176:179], v[104:107], v[64:79]
  ds_read_b64_tr_b16 v[100:101], v2 offset:53248
  ds_read_b64_tr_b16 v[102:103], v2 offset:53504
  v_cvt_pk_bf16_f32 v112, v56, v57
  v_cvt_pk_bf16_f32 v113, v58, v59
  v_cvt_pk_bf16_f32 v114, v60, v61
  v_cvt_pk_bf16_f32 v115, v62, v63
  v_mfma_f32_32x32x16_bf16 v[80:95], a[180:183], v[104:107], v[80:95]
  buffer_load_dwordx4 v119, s[36:39], s53 offen offset:3072 lds
  v_max3_u32 v128, v128, v145, v146
  v_max3_u32 v128, v128, v147, v148
  v_max3_u32 v128, v128, v149, v150
  v_max3_u32 v128, v128, v151, v152
  s_waitcnt lgkmcnt(2)
  v_mfma_f32_32x32x16_bf16 v[64:79], a[184:187], v[96:99], v[64:79]
  ds_read_b64_tr_b16 v[104:105], v2 offset:54272
  ds_read_b64_tr_b16 v[106:107], v2 offset:54528
  v_mfma_f32_32x32x16_bf16 v[80:95], a[188:191], v[96:99], v[80:95]
  v_max3_u32 v128, v128, v153, v154
  v_max_u32 v128, v128, v155
  s_waitcnt lgkmcnt(2)
  v_mfma_f32_32x32x16_bf16 v[64:79], a[192:195], v[100:103], v[64:79]
  ds_read_b64_tr_b16 v[96:97], v2 offset:55296
  ds_read_b64_tr_b16 v[98:99], v2 offset:55552
  s_add_u32 s82, s99, 0
  buffer_store_dwordx4 v[108:111], v5, s[4:7], s82 offen offset:0 sc1
  buffer_store_dwordx4 v[112:115], v5, s[4:7], s82 offen offset:512 sc1
  v_mfma_f32_32x32x16_bf16 v[80:95], a[196:199], v[100:103], v[80:95]
  s_waitcnt lgkmcnt(2)
  v_mfma_f32_32x32x16_bf16 v[64:79], a[200:203], v[104:107], v[64:79]
  ds_read_b64_tr_b16 v[100:101], v2 offset:56320
  ds_read_b64_tr_b16 v[102:103], v2 offset:56576
  v_mfma_f32_32x32x16_bf16 v[80:95], a[204:207], v[104:107], v[80:95]
  v_cmp_eq_u32 vcc, -1, v128
  s_nop 4
  s_cbranch_vccnz L_mk_28
L_mkb_29:
  s_barrier
  s_waitcnt lgkmcnt(2)
  v_mfma_f32_32x32x16_bf16 v[64:79], a[208:211], v[96:99], v[64:79]
  ds_read_b64_tr_b16 v[104:105], v3 offset:0
  ds_read_b64_tr_b16 v[106:107], v3 offset:256
  v_mfma_f32_32x32x16_bf16 v[80:95], a[212:215], v[96:99], v[80:95]
  s_add_u32 m0, s98, 0
  s_add_u32 s80, s86, 86016
  buffer_load_dwordx4 v4, s[4:7], s80 offen offset:0 sc1 lds
  s_waitcnt lgkmcnt(2)
  v_mfma_f32_32x32x16_bf16 v[64:79], a[216:219], v[100:103], v[64:79]
  ds_read_b64_tr_b16 v[96:97], v3 offset:1024
  ds_read_b64_tr_b16 v[98:99], v3 offset:1280
  v_mfma_f32_32x32x16_bf16 v[80:95], a[220:223], v[100:103], v[80:95]
  buffer_load_dwordx4 v4, s[4:7], s80 offen offset:1024 sc1 lds
  s_waitcnt lgkmcnt(2)
  v_mfma_f32_32x32x16_bf16 v[32:47], a[0:3], v[104:107], 0
  ds_read_b64_tr_b16 v[100:101], v3 offset:2048
  ds_read_b64_tr_b16 v[102:103], v3 offset:2304
  s_waitcnt vmcnt(5)
  s_mov_b32 s92, 40000
L_stl_30:
  v_cmp_eq_u32 vcc, 0, v12
  s_nop 4
  s_cbranch_vccz L_sto_31
  buffer_load_dword v12, v6, s[4:7], 0 offen offset:128 sc1
  s_waitcnt vmcnt(0)
  s_sub_u32 s92, s92, 1
  s_cmp_lg_u32 s92, 0
  s_cbranch_scc1 L_stl_30
L_sto_31:
  v_mfma_f32_32x32x16_bf16 v[48:63], a[4:7], v[104:107], 0
  buffer_load_dwordx4 v4, s[4:7], s80 offen offset:2048 sc1 lds
  v_and_b32 v14, 0xffff0000, v12
  v_and_b32 v17, 0xffff, v12
  v_rcp_f32 v15, v14
  s_waitcnt lgkmcnt(2)
  v_mfma_f32_32x32x16_bf16 v[32:47], a[8:11], v[96:99], v[32:47]
  ds_read_b64_tr_b16 v[104:105], v3 offset:3072
  ds_read_b64_tr_b16 v[106:107], v3 offset:3328
  v_xor_b32 v17, 0x8000, v17
  v_cndmask_b32 v17, 0, v17, s[94:95]
  v_lshl_or_b32 v16, v17, 16, v17
  v_mul_f32 v15, 0xbfb8aa3b, v15
  v_mfma_f32_32x32x16_bf16 v[48:63], a[12:15], v[96:99], v[48:63]
  buffer_load_dwordx4 v4, s[4:7], s80 offen offset:3072 sc1 lds
  s_nop 0
  v_mfma_f32_32x32x16_bf16 v[64:79], v[20:23], v[16:19], v[64:79]
  v_mfma_f32_32x32x16_bf16 v[80:95], v[24:27], v[16:19], v[80:95]
  s_waitcnt lgkmcnt(2)
  v_mfma_f32_32x32x16_bf16 v[32:47], a[16:19], v[100:103], v[32:47]
  ds_read_b64_tr_b16 v[96:97], v3 offset:4096
  ds_read_b64_tr_b16 v[98:99], v3 offset:4352
  v_mfma_f32_32x32x16_bf16 v[48:63], a[20:23], v[100:103], v[48:63]
  ds_read_b64_tr_b16 v[192:193], v8 offset:0
  ds_read_b64_tr_b16 v[194:195], v8 offset:1024
  s_add_u32 m0, s98, 4096
  s_add_u32 s80, s86, 90112
  buffer_load_dwordx4 v4, s[4:7], s80 offen offset:0 sc1 lds
  s_waitcnt lgkmcnt(4)
  v_mfma_f32_32x32x16_bf16 v[32:47], a[24:27], v[104:107], v[32:47]
  ds_read_b64_tr_b16 v[100:101], v3 offset:5120
  ds_read_b64_tr_b16 v[102:103], v3 offset:5376
  v_mfma_f32_32x32x16_bf16 v[48:63], a[28:31], v[104:107], v[48:63]
  ds_read_b64_tr_b16 v[196:197], v9 offset:0
  ds_read_b64_tr_b16 v[198:199], v9 offset:1024
  buffer_load_dwordx4 v4, s[4:7], s80 offen offset:1024 sc1 lds
  s_waitcnt lgkmcnt(6)
  v_mfma_f32_32x32x16_bf16 v[32:47], a[32:35], v[96:99], v[32:47]
  ds_read_b64_tr_b16 v[104:105], v3 offset:6144
  ds_read_b64_tr_b16 v[106:107], v3 offset:6400
  v_mul_f32 v64, v64, v15
  v_mul_f32 v65, v65, v15
  v_mul_f32 v66, v66, v15
  v_mul_f32 v67, v67, v15
  v_mfma_f32_32x32x16_bf16 v[48:63], a[36:39], v[96:99], v[48:63]
  ds_read_b64_tr_b16 v[200:201], v10 offset:0
  ds_read_b64_tr_b16 v[202:203], v10 offset:1024
  buffer_load_dwordx4 v4, s[4:7], s80 offen offset:2048 sc1 lds
  v_mul_f32 v68, v68, v15
  v_mul_f32 v69, v69, v15
  s_waitcnt lgkmcnt(6)
  v_mfma_f32_32x32x16_bf16 v[32:47], a[40:43], v[100:103], v[32:47]
  ds_read_b64_tr_b16 v[96:97], v3 offset:7168
  ds_read_b64_tr_b16 v[98:99], v3 offset:7424
  v_mul_f32 v70, v70, v15
  v_mul_f32 v71, v71, v15
  v_exp_f32 v64, v64
  v_mfma_f32_32x32x16_bf16 v[48:63], a[44:47], v[100:103], v[48:63]
  ds_read_b64_tr_b16 v[204:205], v11 offset:0
  ds_read_b64_tr_b16 v[206:207], v11 offset:1024
  v_exp_f32 v65, v65
  s_waitcnt lgkmcnt(6)
  v_mfma_f32_32x32x16_bf16 v[32:47], a[48:51], v[104:107], v[32:47]
  ds_read_b64_tr_b16 v[100:101], v3 offset:8192
  ds_read_b64_tr_b16 v[102:103], v3 offset:8448
  v_exp_f32 v66, v66
  v_exp_f32 v67, v67
  v_mfma_f32_32x32x16_bf16 v[48:63], a[52:55], v[104:107], v[48:63]
  ds_read_b64_tr_b16 v[208:209], v8 offset:4096
  ds_read_b64_tr_b16 v[210:211], v8 offset:5120
  v_exp_f32 v68, v68
  s_waitcnt lgkmcnt(6)
  v_mfma_f32_32x32x16_bf16 v[32:47], a[56:59], v[96:99], v[32:47]
  ds_read_b64_tr_b16 v[104:105], v3 offset:9216
  ds_read_b64_tr_b16 v[106:107], v3 offset:9472
  v_exp_f32 v69, v69
  v_exp_f32 v70, v70
  v_mfma_f32_32x32x16_bf16 v[48:63], a[60:63], v[96:99], v[48:63]
  ds_read_b64_tr_b16 v[212:213], v9 offset:4096
  ds_read_b64_tr_b16 v[214:215], v9 offset:5120
  s_waitcnt lgkmcnt(8)
  s_add_u32 m0, s85, 0
  s_mul_i32 s53, s66, 28
  s_add_u32 s53, s53, s84
  buffer_load_dwordx4 v116, s[36:39], s53 offen offset:0 lds
  v_exp_f32 v71, v71
  s_waitcnt lgkmcnt(6)
  v_mfma_f32_32x32x16_bf16 v[32:47], a[64:67], v[100:103], v[32:47]
  ds_read_b64_tr_b16 v[96:97], v3 offset:10240
  ds_read_b64_tr_b16 v[98:99], v3 offset:10496
  v_fma_f32 v64, v64, v14, v14
  v_fma_f32 v65, v65, v14, v14
  v_fma_f32 v66, v66, v14, v14
  v_fma_f32 v67, v67, v14, v14
  v_mfma_f32_32x32x16_bf16 v[48:63], a[68:71], v[100:103], v[48:63]
  ds_read_b64_tr_b16 v[216:217], v10 offset:4096
  ds_read_b64_tr_b16 v[218:219], v10 offset:5120
  buffer_load_dwordx4 v117, s[36:39], s53 offen offset:1024 lds
  v_fma_f32 v68, v68, v14, v14
  v_fma_f32 v69, v69, v14, v14
  s_waitcnt lgkmcnt(6)
  v_mfma_f32_32x32x16_bf16 v[32:47], a[72:75], v[104:107], v[32:47]
  ds_read_b64_tr_b16 v[100:101], v3 offset:11264
  ds_read_b64_tr_b16 v[102:103], v3 offset:11520
  v_fma_f32 v70, v70, v14, v14
  v_fma_f32 v71, v71, v14, v14
  v_rcp_f32 v64, v64
  v_mfma_f32_32x32x16_bf16 v[48:63], a[76:79], v[104:107], v[48:63]
  ds_read_b64_tr_b16 v[220:221], v11 offset:4096
  ds_read_b64_tr_b16 v[222:223], v11 offset:5120
  buffer_load_dwordx4 v118, s[36:39], s53 offen offset:2048 lds
  v_rcp_f32 v65, v65
  s_waitcnt lgkmcnt(6)
  v_mfma_f32_32x32x16_bf16 v[32:47], a[80:83], v[96:99], v[32:47]
  ds_read_b64_tr_b16 v[104:105], v3 offset:12288
  ds_read_b64_tr_b16 v[106:107], v3 offset:12544
  v_rcp_f32 v66, v66
  v_rcp_f32 v67, v67
  v_mfma_f32_32x32x16_bf16 v[48:63], a[84:87], v[96:99], v[48:63]
  ds_read_b64_tr_b16 v[224:225], v8 offset:8192
  ds_read_b64_tr_b16 v[226:227], v8 offset:9216
  buffer_load_dwordx4 v119, s[36:39], s53 offen offset:3072 lds
  v_rcp_f32 v68, v68
  s_waitcnt lgkmcnt(6)
  v_mfma_f32_32x32x16_bf16 v[32:47], a[88:91], v[100:103], v[32:47]
  ds_read_b64_tr_b16 v[96:97], v3 offset:13312
  ds_read_b64_tr_b16 v[98:99], v3 offset:13568
  v_rcp_f32 v69, v69
  v_rcp_f32 v70, v70
  v_mfma_f32_32x32x16_bf16 v[48:63], a[92:95], v[100:103], v[48:63]
  ds_read_b64_tr_b16 v[228:229], v9 offset:8192
  ds_read_b64_tr_b16 v[230:231], v9 offset:9216
  s_waitcnt lgkmcnt(8)
  s_add_u32 m0, s85, 4096
  s_mul_i32 s53, s67, 28
  s_add_u32 s53, s53, s84
  buffer_load_dwordx4 v116, s[36:39], s53 offen offset:0 lds
  v_rcp_f32 v71, v71
  s_waitcnt lgkmcnt(6)
  v_mfma_f32_32x32x16_bf16 v[32:47], a[96:99], v[104:107], v[32:47]
  ds_read_b64_tr_b16 v[100:101], v3 offset:14336
  ds_read_b64_tr_b16 v[102:103], v3 offset:14592
  v_mul_f32 v72, v72, v64
  v_mul_f32 v73, v73, v65
  v_mul_f32 v74, v74, v66
  v_mul_f32 v75, v75, v67
  v_mfma_f32_32x32x16_bf16 v[48:63], a[100:103], v[104:107], v[48:63]
  ds_read_b64_tr_b16 v[232:233], v10 offset:8192
  ds_read_b64_tr_b16 v[234:235], v10 offset:9216
  buffer_load_dwordx4 v117, s[36:39], s53 offen offset:1024 lds
  v_mul_f32 v76, v76, v68
  v_mul_f32 v77, v77, v69
  s_waitcnt lgkmcnt(6)
  v_mfma_f32_32x32x16_bf16 v[32:47], a[104:107], v[96:99], v[32:47]
  ds_read_b64_tr_b16 v[104:105], v3 offset:15360
  ds_read_b64_tr_b16 v[106:107], v3 offset:15616
  v_mul_f32 v78, v78, v70
  v_mul_f32 v79, v79, v71
  v_cvt_pk_bf16_f32 v108, v72, v73
  v_cvt_pk_bf16_f32 v109, v74, v75
  v_mfma_f32_32x32x16_bf16 v[48:63], a[108:111], v[96:99], v[48:63]
  ds_read_b64_tr_b16 v[236:237], v11 offset:8192
  ds_read_b64_tr_b16 v[238:239], v11 offset:9216
  buffer_load_dwordx4 v118, s[36:39], s53 offen offset:2048 lds
  v_cvt_pk_bf16_f32 v110, v76, v77
  v_cvt_pk_bf16_f32 v111, v78, v79
  s_waitcnt lgkmcnt(6)
  v_mfma_f32_32x32x16_bf16 v[32:47], a[112:115], v[100:103], v[32:47]
  ds_read_b64_tr_b16 v[96:97], v3 offset:16384
  ds_read_b64_tr_b16 v[98:99], v3 offset:16640
  v_mul_f32 v80, v80, v15
  v_mul_f32 v81, v81, v15
  v_mul_f32 v82, v82, v15
  v_mul_f32 v83, v83, v15
  v_mfma_f32_32x32x16_bf16 v[48:63], a[116:119], v[100:103], v[48:63]
  s_waitcnt vmcnt(16)
  ds_read_b64_tr_b16 v[240:241], v8 offset:12288
  ds_read_b64_tr_b16 v[242:243], v8 offset:13312
  buffer_load_dwordx4 v119, s[36:39], s53 offen offset:3072 lds
  v_mul_f32 v84, v84, v15
  v_mul_f32 v85, v85, v15
  s_waitcnt lgkmcnt(6)
  v_mfma_f32_32x32x16_bf16 v[32:47], a[120:123], v[104:107], v[32:47]
  ds_read_b64_tr_b16 v[100:101], v3 offset:17408
  ds_read_b64_tr_b16 v[102:103], v3 offset:17664
  v_mul_f32 v86, v86, v15
  v_mul_f32 v87, v87, v15
  v_exp_f32 v80, v80
  v_mfma_f32_32x32x16_bf16 v[48:63], a[124:127], v[104:107], v[48:63]
  ds_read_b64_tr_b16 v[244:245], v9 offset:12288
  ds_read_b64_tr_b16 v[246:247], v9 offset:13312
  s_waitcnt lgkmcnt(8)
  s_add_u32 m0, s85, 8192
  s_mul_i32 s53, s68, 28
  s_add_u32 s53, s53, s84
  buffer_load_dwordx4 v116, s[36:39], s53 offen offset:0 lds
  v_exp_f32 v81, v81
  s_waitcnt vmcnt(9)
  ds_read_b128 v[128:131], v122 offset:0
  ds_read_b128 v[132:135], v122 offset:1024
  s_waitcnt lgkmcnt(8)
  v_mfma_f32_32x32x16_bf16 v[32:47], a[128:131], v[96:99], v[32:47]
  ds_read_b64_tr_b16 v[104:105], v3 offset:18432
  ds_read_b64_tr_b16 v[106:107], v3 offset:18688
  v_exp_f32 v82, v82
  v_exp_f32 v83, v83
  v_mfma_f32_32x32x16_bf16 v[48:63], a[132:135], v[96:99], v[48:63]
  ds_read_b64_tr_b16 v[248:249], v10 offset:12288
  ds_read_b64_tr_b16 v[250:251], v10 offset:13312
  buffer_load_dwordx4 v117, s[36:39], s53 offen offset:1024 lds
  v_exp_f32 v84, v84
  ds_read_b128 v[136:139], v122 offset:2048
  ds_read_b128 v[140:143], v122 offset:3072
  s_waitcnt lgkmcnt(10)
  v_mfma_f32_32x32x16_bf16 v[32:47], a[136:139], v[100:103], v[32:47]
  ds_read_b64_tr_b16 v[96:97], v3 offset:19456
  ds_read_b64_tr_b16 v[98:99], v3 offset:19712
  v_exp_f32 v85, v85
  v_exp_f32 v86, v86
  v_mfma_f32_32x32x16_bf16 v[48:63], a[140:143], v[100:103], v[48:63]
  ds_read_b64_tr_b16 v[252:253], v11 offset:12288
  ds_read_b64_tr_b16 v[254:255], v11 offset:13312
  buffer_load_dwordx4 v118, s[36:39], s53 offen offset:2048 lds
  v_exp_f32 v87, v87
  ds_read_b128 v[144:147], v122 offset:4096
  ds_read_b128 v[148:151], v122 offset:5120
  s_waitcnt lgkmcnt(10)
  v_mfma_f32_32x32x16_bf16 v[32:47], a[144:147], v[104:107], v[32:47]
  ds_read_b64_tr_b16 v[100:101], v3 offset:20480
  ds_read_b64_tr_b16 v[102:103], v3 offset:20736
  v_fma_f32 v80, v80, v14, v14
  v_fma_f32 v81, v81, v14, v14
  v_fma_f32 v82, v82, v14, v14
  v_fma_f32 v83, v83, v14, v14
  v_mfma_f32_32x32x16_bf16 v[48:63], a[148:151], v[104:107], v[48:63]
  buffer_load_dwordx4 v119, s[36:39], s53 offen offset:3072 lds
  v_fma_f32 v84, v84, v14, v14
  v_fma_f32 v85, v85, v14, v14
  v_fma_f32 v86, v86, v14, v14
  v_fma_f32 v87, v87, v14, v14
  ds_read_b128 v[152:155], v122 offset:6144
  s_waitcnt lgkmcnt(7)
  v_mfma_f32_32x32x16_bf16 v[32:47], a[152:155], v[96:99], v[32:47]
  ds_read_b64_tr_b16 v[104:105], v3 offset:21504
  ds_read_b64_tr_b16 v[106:107], v3 offset:21760
  v_rcp_f32 v80, v80
  v_rcp_f32 v81, v81
  v_mfma_f32_32x32x16_bf16 v[48:63], a[156:159], v[96:99], v[48:63]
  s_waitcnt lgkmcnt(7)
  s_add_u32 m0, s85, 12288
  s_mul_i32 s53, s69, 28
  s_add_u32 s53, s53, s84
  buffer_load_dwordx4 v116, s[36:39], s53 offen offset:0 lds
  v_rcp_f32 v82, v82
  v_rcp_f32 v83, v83
  s_waitcnt lgkmcnt(3)
  v_mfma_f32_32x32x16_bf16 v[32:47], a[160:163], v[100:103], v[32:47]
  ds_read_b64_tr_b16 v[96:97], v3 offset:22528
  ds_read_b64_tr_b16 v[98:99], v3 offset:22784
  v_rcp_f32 v84, v84
  v_rcp_f32 v85, v85
  v_mfma_f32_32x32x16_bf16 v[48:63], a[164:167], v[100:103], v[48:63]
  buffer_load_dwordx4 v117, s[36:39], s53 offen offset:1024 lds
  v_rcp_f32 v86, v86
  v_rcp_f32 v87, v87
  s_waitcnt lgkmcnt(4)
  v_max3_u32 v128, v128, v129, v130
  v_max3_u32 v128, v128, v131, v132
  v_max3_u32 v128, v128, v133, v134
  v_max3_u32 v128, v128, v135, v136
  s_waitcnt lgkmcnt(2)
  v_mfma_f32_32x32x16_bf16 v[32:47], a[168:171], v[104:107], v[32:47]
  ds_read_b64_tr_b16 v[100:101], v3 offset:23552
  ds_read_b64_tr_b16 v[102:103], v3 offset:23808
  v_mul_f32 v88, v88, v80
  v_mul_f32 v89, v89, v81
  v_mul_f32 v90, v90, v82
  v_mul_f32 v91, v91, v83
  v_mfma_f32_32x32x16_bf16 v[48:63], a[172:175], v[104:107], v[48:63]
  buffer_load_dwordx4 v118, s[36:39], s53 offen offset:2048 lds
  v_mul_f32 v92, v92, v84
  v_mul_f32 v93, v93, v85
  v_mul_f32 v94, v94, v86
  v_mul_f32 v95, v95, v87
  v_max3_u32 v128, v128, v137, v138
  v_max3_u32 v128, v128, v139, v140
  v_max3_u32 v128, v128, v141, v142
  v_max3_u32 v128, v128, v143, v144
  buffer_load_dword v123, v6, s[4:7], 0 offen offset:256 sc1
  s_waitcnt lgkmcnt(2)
  v_mfma_f32_32x32x16_bf16 v[32:47], a[176:179], v[96:99], v[32:47]
  ds_read_b64_tr_b16 v[104:105], v3 offset:24576
  ds_read_b64_tr_b16 v[106:107], v3 offset:24832
  v_cvt_pk_bf16_f32 v112, v88, v89
  v_cvt_pk_bf16_f32 v113, v90, v91
  v_cvt_pk_bf16_f32 v114, v92, v93
  v_cvt_pk_bf16_f32 v115, v94, v95
  v_mfma_f32_32x32x16_bf16 v[48:63], a[180:183], v[96:99], v[48:63]
  buffer_load_dwordx4 v119, s[36:39], s53 offen offset:3072 lds
  v_max3_u32 v128, v128, v145, v146
  v_max3_u32 v128, v128, v147, v148
  v_max3_u32 v128, v128, v149, v150
  v_max3_u32 v128, v128, v151, v152
  s_waitcnt lgkmcnt(2)
  v_mfma_f32_32x32x16_bf16 v[32:47], a[184:187], v[100:103], v[32:47]
  ds_read_b64_tr_b16 v[96:97], v3 offset:25600
  ds_read_b64_tr_b16 v[98:99], v3 offset:25856
  v_mfma_f32_32x32x16_bf16 v[48:63], a[188:191], v[100:103], v[48:63]
  v_max3_u32 v128, v128, v153, v154
  v_max_u32 v128, v128, v155
  s_waitcnt lgkmcnt(2)
  v_mfma_f32_32x32x16_bf16 v[32:47], a[192:195], v[104:107], v[32:47]
  ds_read_b64_tr_b16 v[100:101], v3 offset:26624
  ds_read_b64_tr_b16 v[102:103], v3 offset:26880
  s_add_u32 s82, s99, 114688
  buffer_store_dwordx4 v[108:111], v5, s[4:7], s82 offen offset:0 sc1
  buffer_store_dwordx4 v[112:115], v5, s[4:7], s82 offen offset:512 sc1
  v_mfma_f32_32x32x16_bf16 v[48:63], a[196:199], v[104:107], v[48:63]
  s_waitcnt lgkmcnt(2)
  v_mfma_f32_32x32x16_bf16 v[32:47], a[200:203], v[96:99], v[32:47]
  ds_read_b64_tr_b16 v[104:105], v3 offset:27648
  ds_read_b64_tr_b16 v[106:107], v3 offset:27904
  v_mfma_f32_32x32x16_bf16 v[48:63], a[204:207], v[96:99], v[48:63]
  v_cmp_eq_u32 vcc, -1, v128
  s_nop 4
  s_cbranch_vccnz L_mk_32
L_mkb_33:
  s_barrier
  s_waitcnt lgkmcnt(2)
  v_mfma_f32_32x32x16_bf16 v[32:47], a[208:211], v[100:103], v[32:47]
  ds_read_b64_tr_b16 v[96:97], v2 offset:0
  ds_read_b64_tr_b16 v[98:99], v2 offset:256
  v_mfma_f32_32x32x16_bf16 v[48:63], a[212:215], v[100:103], v[48:63]
  s_waitcnt lgkmcnt(2)
  v_mfma_f32_32x32x16_bf16 v[32:47], a[216:219], v[104:107], v[32:47]
  ds_read_b64_tr_b16 v[100:101], v2 offset:1024
  ds_read_b64_tr_b16 v[102:103], v2 offset:1280
  v_mfma_f32_32x32x16_bf16 v[48:63], a[220:223], v[104:107], v[48:63]
  s_waitcnt lgkmcnt(2)
  v_mfma_f32_32x32x16_bf16 v[64:79], a[0:3], v[96:99], 0
  ds_read_b64_tr_b16 v[104:105], v2 offset:2048
  ds_read_b64_tr_b16 v[106:107], v2 offset:2304
  s_waitcnt vmcnt(3)
  s_mov_b32 s92, 40000
L_stl_34:
  v_cmp_eq_u32 vcc, 0, v123
  s_nop 4
  s_cbranch_vccz L_sto_35
  buffer_load_dword v123, v6, s[4:7], 0 offen offset:256 sc1
  s_waitcnt vmcnt(0)
  s_sub_u32 s92, s92, 1
  s_cmp_lg_u32 s92, 0
  s_cbranch_scc1 L_stl_34
L_sto_35:
  v_mfma_f32_32x32x16_bf16 v[80:95], a[4:7], v[96:99], 0
  v_lshrrev_b32 v120, 1, v1
  v_lshlrev_b32 v120, 6, v120
  v_and_b32 v29, 1, v1
  v_lshl_add_u32 v120, v29, 4, v120
  s_lshl_b32 s76, s89, 2
  s_add_u32 s76, s76, s3
  s_mul_i32 s76, s76, 28672
  s_lshl_b32 s77, s91, 12
  s_add_u32 s76, s76, s77
  s_lshl_b32 s77, s90, 5
  s_add_u32 s76, s76, s77
  s_add_u32 s76, s76, 4194304
  s_lshl_b32 s77, s3, 11
  s_add_u32 m0, s77, 151552
  s_nop 0
  buffer_load_dwordx4 v120, s[4:7], s76 offen sc1 lds
  v_and_b32 v14, 0xffff0000, v123
  v_and_b32 v17, 0xffff, v123
  v_rcp_f32 v15, v14
  s_waitcnt lgkmcnt(2)
  v_mfma_f32_32x32x16_bf16 v[64:79], a[8:11], v[100:103], v[64:79]
  ds_read_b64_tr_b16 v[96:97], v2 offset:3072
  ds_read_b64_tr_b16 v[98:99], v2 offset:3328
  v_xor_b32 v17, 0x8000, v17
  v_cndmask_b32 v17, 0, v17, s[94:95]
  v_lshl_or_b32 v16, v17, 16, v17
  v_mul_f32 v15, 0xbfb8aa3b, v15
  v_mfma_f32_32x32x16_bf16 v[80:95], a[12:15], v[100:103], v[80:95]
  s_add_u32 s76, s76, 2048
  s_add_u32 m0, s77, 152576
  s_nop 0
  buffer_load_dwordx4 v120, s[4:7], s76 offen sc1 lds
  s_nop 0
  v_mfma_f32_32x32x16_bf16 v[32:47], v[20:23], v[16:19], v[32:47]
  v_mfma_f32_32x32x16_bf16 v[48:63], v[24:27], v[16:19], v[48:63]
  s_waitcnt lgkmcnt(2)
  v_mfma_f32_32x32x16_bf16 v[64:79], a[16:19], v[104:107], v[64:79]
  ds_read_b64_tr_b16 v[100:101], v2 offset:4096
  ds_read_b64_tr_b16 v[102:103], v2 offset:4352
  v_mfma_f32_32x32x16_bf16 v[80:95], a[20:23], v[104:107], v[80:95]
  ds_read_b64_tr_b16 v[128:129], v8 offset:0
  ds_read_b64_tr_b16 v[130:131], v8 offset:1024
  s_waitcnt lgkmcnt(4)
  v_mfma_f32_32x32x16_bf16 v[64:79], a[24:27], v[96:99], v[64:79]
  ds_read_b64_tr_b16 v[104:105], v2 offset:5120
  ds_read_b64_tr_b16 v[106:107], v2 offset:5376
  v_mfma_f32_32x32x16_bf16 v[80:95], a[28:31], v[96:99], v[80:95]
  ds_read_b64_tr_b16 v[132:133], v9 offset:0
  ds_read_b64_tr_b16 v[134:135], v9 offset:1024
  s_waitcnt lgkmcnt(6)
  v_mfma_f32_32x32x16_bf16 v[64:79], a[32:35], v[100:103], v[64:79]
  ds_read_b64_tr_b16 v[96:97], v2 offset:6144
  ds_read_b64_tr_b16 v[98:99], v2 offset:6400
  v_mul_f32 v32, v32, v15
  v_mul_f32 v33, v33, v15
  v_mul_f32 v34, v34, v15
  v_mul_f32 v35, v35, v15
  v_mfma_f32_32x32x16_bf16 v[80:95], a[36:39], v[100:103], v[80:95]
  ds_read_b64_tr_b16 v[136:137], v10 offset:0
  ds_read_b64_tr_b16 v[138:139], v10 offset:1024
  v_mul_f32 v36, v36, v15
  v_mul_f32 v37, v37, v15
  v_mul_f32 v38, v38, v15
  s_waitcnt lgkmcnt(6)
  v_mfma_f32_32x32x16_bf16 v[64:79], a[40:43], v[104:107], v[64:79]
  ds_read_b64_tr_b16 v[100:101], v2 offset:7168
  ds_read_b64_tr_b16 v[102:103], v2 offset:7424
  v_mul_f32 v39, v39, v15
  v_exp_f32 v32, v32
  v_mfma_f32_32x32x16_bf16 v[80:95], a[44:47], v[104:107], v[80:95]
  ds_read_b64_tr_b16 v[140:141], v11 offset:0
  ds_read_b64_tr_b16 v[142:143], v11 offset:1024
  v_exp_f32 v33, v33
  s_waitcnt lgkmcnt(6)
  v_mfma_f32_32x32x16_bf16 v[64:79], a[48:51], v[96:99], v[64:79]
  ds_read_b64_tr_b16 v[104:105], v2 offset:8192
  ds_read_b64_tr_b16 v[106:107], v2 offset:8448
  v_exp_f32 v34, v34
  v_exp_f32 v35, v35
  v_mfma_f32_32x32x16_bf16 v[80:95], a[52:55], v[96:99], v[80:95]
  ds_read_b64_tr_b16 v[144:145], v8 offset:4096
  ds_read_b64_tr_b16 v[146:147], v8 offset:5120
  v_exp_f32 v36, v36
  s_waitcnt lgkmcnt(6)
  v_mfma_f32_32x32x16_bf16 v[64:79], a[56:59], v[100:103], v[64:79]
  ds_read_b64_tr_b16 v[96:97], v2 offset:9216
  ds_read_b64_tr_b16 v[98:99], v2 offset:9472
  v_exp_f32 v37, v37
  v_exp_f32 v38, v38
  v_mfma_f32_32x32x16_bf16 v[80:95], a[60:63], v[100:103], v[80:95]
  ds_read_b64_tr_b16 v[148:149], v9 offset:4096
  ds_read_b64_tr_b16 v[150:151], v9 offset:5120
  s_waitcnt lgkmcnt(8)
  s_add_u32 m0, s85, 0
  s_mul_i32 s53, s70, 28
  s_add_u32 s53, s53, s84
  buffer_load_dwordx4 v116, s[36:39], s53 offen offset:0 lds
  v_exp_f32 v39, v39
  s_waitcnt lgkmcnt(6)
  v_mfma_f32_32x32x16_bf16 v[64:79], a[64:67], v[104:107], v[64:79]
  ds_read_b64_tr_b16 v[100:101], v2 offset:10240
  ds_read_b64_tr_b16 v[102:103], v2 offset:10496
  v_fma_f32 v32, v32, v14, v14
  v_fma_f32 v33, v33, v14, v14
  v_fma_f32 v34, v34, v14, v14
  v_fma_f32 v35, v35, v14, v14
  v_mfma_f32_32x32x16_bf16 v[80:95], a[68:71], v[104:107], v[80:95]
  ds_read_b64_tr_b16 v[152:153], v10 offset:4096
  ds_read_b64_tr_b16 v[154:155], v10 offset:5120
  buffer_load_dwordx4 v117, s[36:39], s53 offen offset:1024 lds
  v_fma_f32 v36, v36, v14, v14
  v_fma_f32 v37, v37, v14, v14
  s_waitcnt lgkmcnt(6)
  v_mfma_f32_32x32x16_bf16 v[64:79], a[72:75], v[96:99], v[64:79]
  ds_read_b64_tr_b16 v[104:105], v2 offset:11264
  ds_read_b64_tr_b16 v[106:107], v2 offset:11520
  v_fma_f32 v38, v38, v14, v14
  v_fma_f32 v39, v39, v14, v14
  v_rcp_f32 v32, v32
  v_mfma_f32_32x32x16_bf16 v[80:95], a[76:79], v[96:99], v[80:95]
  ds_read_b64_tr_b16 v[156:157], v11 offset:4096
  ds_read_b64_tr_b16 v[158:159], v11 offset:5120
  buffer_load_dwordx4 v118, s[36:39], s53 offen offset:2048 lds
  v_rcp_f32 v33, v33
  s_waitcnt lgkmcnt(6)
  v_mfma_f32_32x32x16_bf16 v[64:79], a[80:83], v[100:103], v[64:79]
  ds_read_b64_tr_b16 v[96:97], v2 offset:12288
  ds_read_b64_tr_b16 v[98:99], v2 offset:12544
  v_rcp_f32 v34, v34
  v_rcp_f32 v35, v35
  v_mfma_f32_32x32x16_bf16 v[80:95], a[84:87], v[100:103], v[80:95]
  ds_read_b64_tr_b16 a[0:1], v8 offset:8192
  ds_read_b64_tr_b16 a[2:3], v8 offset:9216
  buffer_load_dwordx4 v119, s[36:39], s53 offen offset:3072 lds
  v_rcp_f32 v36, v36
  s_waitcnt lgkmcnt(6)
  v_mfma_f32_32x32x16_bf16 v[64:79], a[88:91], v[104:107], v[64:79]
  ds_read_b64_tr_b16 v[100:101], v2 offset:13312
  ds_read_b64_tr_b16 v[102:103], v2 offset:13568
  v_rcp_f32 v37, v37
  v_rcp_f32 v38, v38
  v_mfma_f32_32x32x16_bf16 v[80:95], a[92:95], v[104:107], v[80:95]
  ds_read_b64_tr_b16 a[4:5], v9 offset:8192
  ds_read_b64_tr_b16 a[6:7], v9 offset:9216
  s_waitcnt lgkmcnt(8)
  s_add_u32 m0, s85, 4096
  s_mul_i32 s53, s71, 28
  s_add_u32 s53, s53, s84
  buffer_load_dwordx4 v116, s[36:39], s53 offen offset:0 lds
  v_rcp_f32 v39, v39
  s_waitcnt lgkmcnt(6)
  v_mfma_f32_32x32x16_bf16 v[64:79], a[96:99], v[96:99], v[64:79]
  ds_read_b64_tr_b16 v[104:105], v2 offset:14336
  ds_read_b64_tr_b16 v[106:107], v2 offset:14592
  v_mul_f32 v40, v40, v32
  v_mul_f32 v41, v41, v33
  v_mul_f32 v42, v42, v34
  v_mul_f32 v43, v43, v35
  v_mfma_f32_32x32x16_bf16 v[80:95], a[100:103], v[96:99], v[80:95]
  ds_read_b64_tr_b16 a[8:9], v10 offset:8192
  ds_read_b64_tr_b16 a[10:11], v10 offset:9216
  buffer_load_dwordx4 v117, s[36:39], s53 offen offset:1024 lds
  v_mul_f32 v44, v44, v36
  v_mul_f32 v45, v45, v37
  s_waitcnt lgkmcnt(6)
  v_mfma_f32_32x32x16_bf16 v[64:79], a[104:107], v[100:103], v[64:79]
  ds_read_b64_tr_b16 v[96:97], v2 offset:15360
  ds_read_b64_tr_b16 v[98:99], v2 offset:15616
  v_mul_f32 v46, v46, v38
  v_mul_f32 v47, v47, v39
  v_cvt_pk_bf16_f32 v108, v40, v41
  v_cvt_pk_bf16_f32 v109, v42, v43
  v_mfma_f32_32x32x16_bf16 v[80:95], a[108:111], v[100:103], v[80:95]
  ds_read_b64_tr_b16 a[12:13], v11 offset:8192
  ds_read_b64_tr_b16 a[14:15], v11 offset:9216
  buffer_load_dwordx4 v118, s[36:39], s53 offen offset:2048 lds
  v_cvt_pk_bf16_f32 v110, v44, v45
  v_cvt_pk_bf16_f32 v111, v46, v47
  s_waitcnt lgkmcnt(6)
  v_mfma_f32_32x32x16_bf16 v[64:79], a[112:115], v[104:107], v[64:79]
  ds_read_b64_tr_b16 v[100:101], v2 offset:16384
  ds_read_b64_tr_b16 v[102:103], v2 offset:16640
  v_mul_f32 v48, v48, v15
  v_mul_f32 v49, v49, v15
  v_mul_f32 v50, v50, v15
  v_mul_f32 v51, v51, v15
  v_mfma_f32_32x32x16_bf16 v[80:95], a[116:119], v[104:107], v[80:95]
  s_waitcnt vmcnt(11)
  ds_read_b64_tr_b16 a[16:17], v8 offset:12288
  ds_read_b64_tr_b16 a[18:19], v8 offset:13312
  buffer_load_dwordx4 v119, s[36:39], s53 offen offset:3072 lds
  v_mul_f32 v52, v52, v15
  v_mul_f32 v53, v53, v15
  s_waitcnt lgkmcnt(6)
  v_mfma_f32_32x32x16_bf16 v[64:79], a[120:123], v[96:99], v[64:79]
  ds_read_b64_tr_b16 v[104:105], v2 offset:17408
  ds_read_b64_tr_b16 v[106:107], v2 offset:17664
  v_mul_f32 v54, v54, v15
  v_mul_f32 v55, v55, v15
  v_exp_f32 v48, v48
  v_mfma_f32_32x32x16_bf16 v[80:95], a[124:127], v[96:99], v[80:95]
  ds_read_b64_tr_b16 a[20:21], v9 offset:12288
  ds_read_b64_tr_b16 a[22:23], v9 offset:13312
  s_add_u32 s55, s50, 0
  v_add_u32 v127, s55, v4
  buffer_load_dwordx4 a[64:67], v127, s[4:7], s58 offen sc1
  v_exp_f32 v49, v49
  s_waitcnt lgkmcnt(6)
  v_mfma_f32_32x32x16_bf16 v[64:79], a[128:131], v[100:103], v[64:79]
  ds_read_b64_tr_b16 v[96:97], v2 offset:18432
  ds_read_b64_tr_b16 v[98:99], v2 offset:18688
  v_exp_f32 v50, v50
  v_exp_f32 v51, v51
  v_mfma_f32_32x32x16_bf16 v[80:95], a[132:135], v[100:103], v[80:95]
  ds_read_b64_tr_b16 a[24:25], v10 offset:12288
  ds_read_b64_tr_b16 a[26:27], v10 offset:13312
  buffer_load_dwordx4 a[68:71], v127, s[4:7], s59 offen sc1
  v_exp_f32 v52, v52
  s_waitcnt lgkmcnt(6)
  v_mfma_f32_32x32x16_bf16 v[64:79], a[136:139], v[104:107], v[64:79]
  ds_read_b64_tr_b16 v[100:101], v2 offset:19456
  ds_read_b64_tr_b16 v[102:103], v2 offset:19712
  v_exp_f32 v53, v53
  v_exp_f32 v54, v54
  v_mfma_f32_32x32x16_bf16 v[80:95], a[140:143], v[104:107], v[80:95]
  ds_read_b64_tr_b16 a[28:29], v11 offset:12288
  ds_read_b64_tr_b16 a[30:31], v11 offset:13312
  buffer_load_dwordx4 a[72:75], v127, s[4:7], s60 offen sc1
  v_exp_f32 v55, v55
  s_lshl_b32 s76, s3, 11
  s_add_u32 s76, s76, 151552
  v_add_u32 v125, s76, v4
  s_waitcnt vmcnt(11)
  ds_read_b128 v[116:119], v125 offset:0
  ds_read_b128 v[120:123], v125 offset:1024
  s_waitcnt lgkmcnt(8)
  v_mfma_f32_32x32x16_bf16 v[64:79], a[144:147], v[96:99], v[64:79]
  ds_read_b64_tr_b16 v[104:105], v2 offset:20480
  ds_read_b64_tr_b16 v[106:107], v2 offset:20736
  v_fma_f32 v48, v48, v14, v14
  v_fma_f32 v49, v49, v14, v14
  v_fma_f32 v50, v50, v14, v14
  v_fma_f32 v51, v51, v14, v14
  v_mfma_f32_32x32x16_bf16 v[80:95], a[148:151], v[96:99], v[80:95]
  buffer_load_dwordx4 a[76:79], v127, s[4:7], s61 offen sc1
  v_fma_f32 v52, v52, v14, v14
  v_fma_f32 v53, v53, v14, v14
  v_fma_f32 v54, v54, v14, v14
  v_fma_f32 v55, v55, v14, v14
  s_waitcnt lgkmcnt(6)
  v_mfma_f32_32x32x16_bf16 v[64:79], a[152:155], v[100:103], v[64:79]
  ds_read_b64_tr_b16 v[96:97], v2 offset:21504
  ds_read_b64_tr_b16 v[98:99], v2 offset:21760
  v_rcp_f32 v48, v48
  v_rcp_f32 v49, v49
  v_mfma_f32_32x32x16_bf16 v[80:95], a[156:159], v[100:103], v[80:95]
  buffer_load_dwordx4 a[80:83], v127, s[4:7], s62 offen sc1
  v_rcp_f32 v50, v50
  v_rcp_f32 v51, v51
  s_waitcnt lgkmcnt(2)
  v_mfma_f32_32x32x16_bf16 v[64:79], a[160:163], v[104:107], v[64:79]
  ds_read_b64_tr_b16 v[100:101], v2 offset:22528
  ds_read_b64_tr_b16 v[102:103], v2 offset:22784
  v_rcp_f32 v52, v52
  v_rcp_f32 v53, v53
  v_mfma_f32_32x32x16_bf16 v[80:95], a[164:167], v[104:107], v[80:95]
  buffer_load_dwordx4 a[84:87], v127, s[4:7], s63 offen sc1
  v_rcp_f32 v54, v54
  v_rcp_f32 v55, v55
  v_max3_u32 v116, v116, v117, v118
  v_max3_u32 v116, v116, v119, v120
  v_max3_u32 v116, v116, v121, v122
  v_max_u32 v116, v116, v123
  s_waitcnt lgkmcnt(2)
  v_mfma_f32_32x32x16_bf16 v[64:79], a[168:171], v[96:99], v[64:79]
  ds_read_b64_tr_b16 v[104:105], v2 offset:23552
  ds_read_b64_tr_b16 v[106:107], v2 offset:23808
  v_mul_f32 v56, v56, v48
  v_mul_f32 v57, v57, v49
  v_mul_f32 v58, v58, v50
  v_mul_f32 v59, v59, v51
  v_mfma_f32_32x32x16_bf16 v[80:95], a[172:175], v[96:99], v[80:95]
  buffer_load_dwordx4 a[88:91], v127, s[4:7], s64 offen sc1
  v_mul_f32 v60, v60, v52
  v_mul_f32 v61, v61, v53
  v_mul_f32 v62, v62, v54
  v_mul_f32 v63, v63, v55
  buffer_load_dword v124, v6, s[4:7], 0 offen offset:384 sc1
  s_waitcnt lgkmcnt(2)
  v_mfma_f32_32x32x16_bf16 v[64:79], a[176:179], v[100:103], v[64:79]
  ds_read_b64_tr_b16 v[96:97], v2 offset:24576
  ds_read_b64_tr_b16 v[98:99], v2 offset:24832
  v_cvt_pk_bf16_f32 v112, v56, v57
  v_cvt_pk_bf16_f32 v113, v58, v59
  v_cvt_pk_bf16_f32 v114, v60, v61
  v_cvt_pk_bf16_f32 v115, v62, v63
  v_mfma_f32_32x32x16_bf16 v[80:95], a[180:183], v[100:103], v[80:95]
  buffer_load_dwordx4 a[92:95], v127, s[4:7], s65 offen sc1
  s_add_u32 s82, s99, 229376
  buffer_store_dwordx4 v[108:111], v5, s[4:7], s82 offen offset:0 sc1
  buffer_store_dwordx4 v[112:115], v5, s[4:7], s82 offen offset:512 sc1
  s_waitcnt lgkmcnt(2)
  v_mfma_f32_32x32x16_bf16 v[64:79], a[184:187], v[104:107], v[64:79]
  ds_read_b64_tr_b16 v[100:101], v2 offset:25600
  ds_read_b64_tr_b16 v[102:103], v2 offset:25856
  v_mfma_f32_32x32x16_bf16 v[80:95], a[188:191], v[104:107], v[80:95]
  buffer_load_dwordx4 a[96:99], v127, s[4:7], s66 offen sc1
  s_waitcnt lgkmcnt(2)
  v_mfma_f32_32x32x16_bf16 v[64:79], a[192:195], v[96:99], v[64:79]
  ds_read_b64_tr_b16 v[104:105], v2 offset:26624
  ds_read_b64_tr_b16 v[106:107], v2 offset:26880
  v_mfma_f32_32x32x16_bf16 v[80:95], a[196:199], v[96:99], v[80:95]
  s_waitcnt lgkmcnt(2)
  v_mfma_f32_32x32x16_bf16 v[64:79], a[200:203], v[100:103], v[64:79]
  ds_read_b64_tr_b16 v[96:97], v2 offset:27648
  ds_read_b64_tr_b16 v[98:99], v2 offset:27904
  v_mfma_f32_32x32x16_bf16 v[80:95], a[204:207], v[100:103], v[80:95]
  buffer_load_dwordx4 a[100:103], v127, s[4:7], s67 offen sc1
  v_cmp_eq_u32 vcc, -1, v116
  s_nop 4
  s_cbranch_vccnz L_mk_36
L_mkb_37:
  s_barrier
  s_waitcnt lgkmcnt(2)
  v_mfma_f32_32x32x16_bf16 v[64:79], a[208:211], v[104:107], v[64:79]
  v_mfma_f32_32x32x16_bf16 v[80:95], a[212:215], v[104:107], v[80:95]
  buffer_load_dwordx4 a[104:107], v127, s[4:7], s68 offen sc1
  s_waitcnt lgkmcnt(0)
  v_mfma_f32_32x32x16_bf16 v[64:79], a[216:219], v[96:99], v[64:79]
  v_mfma_f32_32x32x16_bf16 v[80:95], a[220:223], v[96:99], v[80:95]
  buffer_load_dwordx4 a[108:111], v127, s[4:7], s69 offen sc1
  s_waitcnt vmcnt(7)
  s_mov_b32 s92, 40000
L_stl_38:
  v_cmp_eq_u32 vcc, 0, v124
  s_nop 4
  s_cbranch_vccz L_sto_39
  buffer_load_dword v124, v6, s[4:7], 0 offen offset:384 sc1
  s_waitcnt vmcnt(0)
  s_sub_u32 s92, s92, 1
  s_cmp_lg_u32 s92, 0
  s_cbranch_scc1 L_stl_38
L_sto_39:
  v_and_b32 v14, 0xffff0000, v124
  v_and_b32 v17, 0xffff, v124
  v_rcp_f32 v15, v14
  v_xor_b32 v17, 0x8000, v17
  v_cndmask_b32 v17, 0, v17, s[94:95]
  v_lshl_or_b32 v16, v17, 16, v17
  v_mul_f32 v15, 0xbfb8aa3b, v15
  s_nop 0
  v_mfma_f32_32x32x16_bf16 v[64:79], v[20:23], v[16:19], v[64:79]
  v_mfma_f32_32x32x16_bf16 v[80:95], v[24:27], v[16:19], v[80:95]
  s_add_u32 s55, s50, 114688
  v_add_u32 v2, s55, v4
  v_mfma_f32_16x16x32_bf16 v[32:35], a[224:227], a[64:67], 0
  buffer_load_dwordx4 a[112:115], v127, s[4:7], s70 offen sc1
  buffer_load_dwordx4 a[116:119], v127, s[4:7], s71 offen sc1
  v_mfma_f32_16x16x32_bf16 v[36:39], a[228:231], a[64:67], 0
  ds_read_b64_tr_b16 a[32:33], v8 offset:0
  ds_read_b64_tr_b16 a[34:35], v8 offset:1024
  v_mfma_f32_16x16x32_bf16 v[40:43], a[232:235], a[64:67], 0
  ds_read_b64_tr_b16 a[36:37], v9 offset:0
  ds_read_b64_tr_b16 a[38:39], v9 offset:1024
  v_mfma_f32_16x16x32_bf16 v[44:47], a[236:239], a[64:67], 0
  ds_read_b64_tr_b16 a[40:41], v10 offset:0
  ds_read_b64_tr_b16 a[42:43], v10 offset:1024
  v_mfma_f32_16x16x32_bf16 v[32:35], a[240:243], a[68:71], v[32:35]
  ds_read_b64_tr_b16 a[44:45], v11 offset:0
  v_mul_f32 v64, v64, v15
  v_mul_f32 v65, v65, v15
  v_mfma_f32_16x16x32_bf16 v[36:39], a[244:247], a[68:71], v[36:39]
  buffer_load_dwordx4 a[120:123], v2, s[4:7], s58 offen sc1
  v_mul_f32 v66, v66, v15
  v_mul_f32 v67, v67, v15
  v_mfma_f32_16x16x32_bf16 v[40:43], a[248:251], a[68:71], v[40:43]
  v_mul_f32 v68, v68, v15
  v_mul_f32 v69, v69, v15
  v_mfma_f32_16x16x32_bf16 v[44:47], a[252:255], a[68:71], v[44:47]
  ds_read_b64_tr_b16 a[46:47], v11 offset:1024
  v_mul_f32 v70, v70, v15
  v_mul_f32 v71, v71, v15
  v_mfma_f32_16x16x32_bf16 v[32:35], v[160:163], a[72:75], v[32:35]
  buffer_load_dwordx4 a[124:127], v2, s[4:7], s59 offen sc1
  v_exp_f32 v64, v64
  v_exp_f32 v65, v65
  v_mfma_f32_16x16x32_bf16 v[36:39], v[164:167], a[72:75], v[36:39]
  v_exp_f32 v66, v66
  v_exp_f32 v67, v67
  v_mfma_f32_16x16x32_bf16 v[40:43], v[168:171], a[72:75], v[40:43]
  ds_read_b64_tr_b16 a[48:49], v8 offset:4096
  v_exp_f32 v68, v68
  v_exp_f32 v69, v69
  v_mfma_f32_16x16x32_bf16 v[44:47], v[172:175], a[72:75], v[44:47]
  buffer_load_dwordx4 a[128:131], v2, s[4:7], s60 offen sc1
  v_exp_f32 v70, v70
  v_exp_f32 v71, v71
  v_mfma_f32_16x16x32_bf16 v[32:35], v[176:179], a[76:79], v[32:35]
  v_fma_f32 v64, v64, v14, v14
  v_fma_f32 v65, v65, v14, v14
  v_mfma_f32_16x16x32_bf16 v[36:39], v[180:183], a[76:79], v[36:39]
  ds_read_b64_tr_b16 a[50:51], v8 offset:5120
  v_fma_f32 v66, v66, v14, v14
  v_fma_f32 v67, v67, v14, v14
  v_mfma_f32_16x16x32_bf16 v[40:43], v[184:187], a[76:79], v[40:43]
  buffer_load_dwordx4 a[132:135], v2, s[4:7], s61 offen sc1
  v_fma_f32 v68, v68, v14, v14
  v_fma_f32 v69, v69, v14, v14
  v_mfma_f32_16x16x32_bf16 v[44:47], v[188:191], a[76:79], v[44:47]
  v_fma_f32 v70, v70, v14, v14
  v_fma_f32 v71, v71, v14, v14
  v_mfma_f32_16x16x32_bf16 v[32:35], v[192:195], a[80:83], v[32:35]
  ds_read_b64_tr_b16 a[52:53], v9 offset:4096
  v_rcp_f32 v64, v64
  v_rcp_f32 v65, v65
  v_mfma_f32_16x16x32_bf16 v[36:39], v[196:199], a[80:83], v[36:39]
  buffer_load_dwordx4 a[136:139], v2, s[4:7], s62 offen sc1
  v_rcp_f32 v66, v66
  v_rcp_f32 v67, v67
  v_mfma_f32_16x16x32_bf16 v[40:43], v[200:203], a[80:83], v[40:43]
  v_rcp_f32 v68, v68
  v_rcp_f32 v69, v69
  v_mfma_f32_16x16x32_bf16 v[44:47], v[204:207], a[80:83], v[44:47]
  ds_read_b64_tr_b16 a[54:55], v9 offset:5120
  v_rcp_f32 v70, v70
  v_rcp_f32 v71, v71
  v_mfma_f32_16x16x32_bf16 v[32:35], v[208:211], a[84:87], v[32:35]
  buffer_load_dwordx4 a[140:143], v2, s[4:7], s63 offen sc1
  v_mul_f32 v72, v72, v64
  v_mul_f32 v73, v73, v65
  v_mfma_f32_16x16x32_bf16 v[36:39], v[212:215], a[84:87], v[36:39]
  v_mul_f32 v74, v74, v66
  v_mul_f32 v75, v75, v67
  v_mfma_f32_16x16x32_bf16 v[40:43], v[216:219], a[84:87], v[40:43]
  ds_read_b64_tr_b16 a[56:57], v10 offset:4096
  v_mul_f32 v76, v76, v68
  v_mul_f32 v77, v77, v69
  v_mfma_f32_16x16x32_bf16 v[44:47], v[220:223], a[84:87], v[44:47]
  buffer_load_dwordx4 a[144:147], v2, s[4:7], s64 offen sc1
  v_mul_f32 v78, v78, v70
  v_mul_f32 v79, v79, v71
  v_mfma_f32_16x16x32_bf16 v[32:35], v[224:227], a[88:91], v[32:35]
  v_cvt_pk_bf16_f32 v108, v72, v73
  v_cvt_pk_bf16_f32 v109, v74, v75
  v_mfma_f32_16x16x32_bf16 v[36:39], v[228:231], a[88:91], v[36:39]
  ds_read_b64_tr_b16 a[58:59], v10 offset:5120
  v_cvt_pk_bf16_f32 v110, v76, v77
  v_cvt_pk_bf16_f32 v111, v78, v79
  v_mfma_f32_16x16x32_bf16 v[40:43], v[232:235], a[88:91], v[40:43]
  buffer_load_dwordx4 a[148:151], v2, s[4:7], s65 offen sc1
  v_mul_f32 v80, v80, v15
  v_mul_f32 v81, v81, v15
  v_mfma_f32_16x16x32_bf16 v[44:47], v[236:239], a[88:91], v[44:47]
  v_mul_f32 v82, v82, v15
  v_mul_f32 v83, v83, v15
  s_waitcnt vmcnt(16)
  v_mfma_f32_16x16x32_bf16 v[32:35], v[240:243], a[92:95], v[32:35]
  ds_read_b64_tr_b16 a[60:61], v11 offset:4096
  v_mul_f32 v84, v84, v15
  v_mul_f32 v85, v85, v15
  v_mfma_f32_16x16x32_bf16 v[36:39], v[244:247], a[92:95], v[36:39]
  buffer_load_dwordx4 a[152:155], v2, s[4:7], s66 offen sc1
  v_mul_f32 v86, v86, v15
  v_mul_f32 v87, v87, v15
  v_mfma_f32_16x16x32_bf16 v[40:43], v[248:251], a[92:95], v[40:43]
  v_exp_f32 v80, v80
  v_exp_f32 v81, v81
  v_mfma_f32_16x16x32_bf16 v[44:47], v[252:255], a[92:95], v[44:47]
  ds_read_b64_tr_b16 a[62:63], v11 offset:5120
  v_exp_f32 v82, v82
  v_exp_f32 v83, v83
  s_waitcnt vmcnt(14)
  v_mfma_f32_16x16x32_bf16 v[32:35], v[128:131], a[96:99], v[32:35]
  buffer_load_dwordx4 a[156:159], v2, s[4:7], s67 offen sc1
  v_exp_f32 v84, v84
  v_exp_f32 v85, v85
  v_mfma_f32_16x16x32_bf16 v[36:39], v[132:135], a[96:99], v[36:39]
  v_exp_f32 v86, v86
  v_exp_f32 v87, v87
  v_mfma_f32_16x16x32_bf16 v[40:43], v[136:139], a[96:99], v[40:43]
  v_fma_f32 v80, v80, v14, v14
  v_fma_f32 v81, v81, v14, v14
  v_mfma_f32_16x16x32_bf16 v[44:47], v[140:143], a[96:99], v[44:47]
  buffer_load_dwordx4 a[160:163], v2, s[4:7], s68 offen sc1
  v_fma_f32 v82, v82, v14, v14
  v_fma_f32 v83, v83, v14, v14
  s_waitcnt vmcnt(15)
  v_mfma_f32_16x16x32_bf16 v[32:35], v[144:147], a[100:103], v[32:35]
  v_fma_f32 v84, v84, v14, v14
  v_fma_f32 v85, v85, v14, v14
  v_mfma_f32_16x16x32_bf16 v[36:39], v[148:151], a[100:103], v[36:39]
  v_fma_f32 v86, v86, v14, v14
  v_fma_f32 v87, v87, v14, v14
  v_mfma_f32_16x16x32_bf16 v[40:43], v[152:155], a[100:103], v[40:43]
  buffer_load_dwordx4 a[164:167], v2, s[4:7], s69 offen sc1
  v_rcp_f32 v80, v80
  v_rcp_f32 v81, v81
  v_mfma_f32_16x16x32_bf16 v[44:47], v[156:159], a[100:103], v[44:47]
  v_rcp_f32 v82, v82
  v_rcp_f32 v83, v83
  s_waitcnt vmcnt(15)
  v_mfma_f32_16x16x32_bf16 v[32:35], a[0:3], a[104:107], v[32:35]
  v_rcp_f32 v84, v84
  v_rcp_f32 v85, v85
  v_mfma_f32_16x16x32_bf16 v[36:39], a[4:7], a[104:107], v[36:39]
  buffer_load_dwordx4 a[168:171], v2, s[4:7], s70 offen sc1
  v_rcp_f32 v86, v86
  v_rcp_f32 v87, v87
  v_mfma_f32_16x16x32_bf16 v[40:43], a[8:11], a[104:107], v[40:43]
  v_mul_f32 v88, v88, v80
  v_mul_f32 v89, v89, v81
  v_mfma_f32_16x16x32_bf16 v[44:47], a[12:15], a[104:107], v[44:47]
  v_mul_f32 v90, v90, v82
  v_mul_f32 v91, v91, v83
  s_waitcnt vmcnt(15)
  v_mfma_f32_16x16x32_bf16 v[32:35], a[16:19], a[108:111], v[32:35]
  buffer_load_dwordx4 a[172:175], v2, s[4:7], s71 offen sc1
  v_mul_f32 v92, v92, v84
  v_mul_f32 v93, v93, v85
  v_mfma_f32_16x16x32_bf16 v[36:39], a[20:23], a[108:111], v[36:39]
  v_mul_f32 v94, v94, v86
  v_mul_f32 v95, v95, v87
  v_mfma_f32_16x16x32_bf16 v[40:43], a[24:27], a[108:111], v[40:43]
  v_cvt_pk_bf16_f32 v112, v88, v89
  v_cvt_pk_bf16_f32 v113, v90, v91
  v_mfma_f32_16x16x32_bf16 v[44:47], a[28:31], a[108:111], v[44:47]
  v_cvt_pk_bf16_f32 v114, v92, v93
  v_cvt_pk_bf16_f32 v115, v94, v95
  s_add_u32 s82, s99, 344064
  buffer_store_dwordx4 v[108:111], v5, s[4:7], s82 offen offset:0 sc1
  buffer_store_dwordx4 v[112:115], v5, s[4:7], s82 offen offset:512 sc1
  s_waitcnt vmcnt(17)
  s_waitcnt lgkmcnt(8)
  v_mfma_f32_16x16x32_bf16 v[32:35], a[32:35], a[112:115], v[32:35]
  v_mfma_f32_16x16x32_bf16 v[36:39], a[36:39], a[112:115], v[36:39]
  v_mfma_f32_16x16x32_bf16 v[40:43], a[40:43], a[112:115], v[40:43]
  v_mfma_f32_16x16x32_bf16 v[44:47], a[44:47], a[112:115], v[44:47]
  s_waitcnt vmcnt(16)
  s_waitcnt lgkmcnt(0)
  v_mfma_f32_16x16x32_bf16 v[32:35], a[48:51], a[116:119], v[32:35]
  v_mfma_f32_16x16x32_bf16 v[36:39], a[52:55], a[116:119], v[36:39]
  v_mfma_f32_16x16x32_bf16 v[40:43], a[56:59], a[116:119], v[40:43]
  v_mfma_f32_16x16x32_bf16 v[44:47], a[60:63], a[116:119], v[44:47]
  s_nop 7
  v_cmp_u_f32 vcc, v32, v32
  s_nop 4
  s_cbranch_vccnz L_redo_40
L_back_41:
  s_add_u32 s55, s50, 229376
  v_add_u32 v2, s55, v4
  v_lshrrev_b32 v7, 4, v1
  v_and_b32 v28, 15, v1
  v_mul_u32_u24 v29, 272, v7
  v_lshl_add_u32 v29, v28, 4, v29
  buffer_load_dwordx4 a[64:67], v2, s[4:7], s58 offen sc1
  s_lshl_b32 s76, s3, 14
  s_add_u32 s76, s76, 86016
  v_add_u32 v13, s76, v29
  s_mul_i32 s76, s3, 1088
  s_add_u32 s76, s76, 28672
  v_add_u32 v15, s76, v29
  v_mul_u32_u24 v29, 272, v28
  s_lshl_b32 s76, s3, 2
  v_add_u32 v14, s76, v7
  v_lshl_add_u32 v29, v14, 4, v29
  s_lshl_b32 s76, s89, 7
  s_lshl_b32 s77, s90, 4
  buffer_load_dwordx4 a[68:71], v2, s[4:7], s59 offen sc1
  s_add_u32 s76, s76, s77
  v_add_u32 v17, s76, v14
  v_mul_u32_u24 v17, 896, v17
  v_lshl_add_u32 v17, v28, 3, v17
  s_lshl_b32 s76, s91, 7
  v_add_u32 v17, s76, v17
  v_add_u32 v14, 86016, v29
  v_add_u32 v16, 28672, v29
  v_lshrrev_b32 v7, 4, v1
  v_bfe_u32 v28, v1, 2, 2
  v_lshl_add_u32 v7, v7, 2, v28
  s_lshl_b32 s76, s3, 4
  buffer_load_dwordx4 a[72:75], v2, s[4:7], s60 offen sc1
  v_add_u32 v7, s76, v7
  v_lshlrev_b32 v7, 5, v7
  v_and_b32 v28, 3, v1
  v_lshl_add_u32 v7, v28, 3, v7
  v_add_u32 v18, 151552, v7
  ds_read_b64_tr_b16 v[84:85], v18 offset:0
  ds_read_b64_tr_b16 v[86:87], v18 offset:2048
  ds_read_b64_tr_b16 v[88:89], v18 offset:4096
  ds_read_b64_tr_b16 v[90:91], v18 offset:6144
  s_waitcnt lgkmcnt(3)
  v_lshlrev_b32 v64, 16, v84
  v_and_b32 v65, 0xffff0000, v84
  buffer_load_dwordx4 a[76:79], v2, s[4:7], s61 offen sc1
  v_lshlrev_b32 v66, 16, v85
  v_and_b32 v67, 0xffff0000, v85
  ds_write_b128 v15, v[64:67] offset:0
  s_waitcnt lgkmcnt(3)
  v_lshlrev_b32 v68, 16, v86
  v_and_b32 v69, 0xffff0000, v86
  v_lshlrev_b32 v70, 16, v87
  v_and_b32 v71, 0xffff0000, v87
  ds_write_b128 v15, v[68:71] offset:4352
  s_waitcnt lgkmcnt(3)
  v_lshlrev_b32 v72, 16, v88
  v_and_b32 v73, 0xffff0000, v88
  v_lshlrev_b32 v74, 16, v89
  v_and_b32 v75, 0xffff0000, v89
  ds_write_b128 v15, v[72:75] offset:8704
  s_waitcnt lgkmcnt(3)
  v_lshlrev_b32 v76, 16, v90
  v_and_b32 v77, 0xffff0000, v90
  v_lshlrev_b32 v78, 16, v91
  v_and_b32 v79, 0xffff0000, v91
  ds_write_b128 v15, v[76:79] offset:13056
  s_waitcnt vmcnt(19)
  v_mfma_f32_16x16x32_bf16 v[48:51], a[224:227], a[120:123], 0
  v_mfma_f32_16x16x32_bf16 v[52:55], a[228:231], a[120:123], 0
  s_waitcnt vmcnt(18)
  v_mfma_f32_16x16x32_bf16 v[48:51], a[240:243], a[124:127], v[48:51]
  buffer_load_dwordx4 a[80:83], v2, s[4:7], s62 offen sc1
  v_mfma_f32_16x16x32_bf16 v[52:55], a[244:247], a[124:127], v[52:55]
  s_waitcnt vmcnt(18)
  v_mfma_f32_16x16x32_bf16 v[48:51], v[160:163], a[128:131], v[48:51]
  ds_write_b128 v13, v[32:35] offset:0
  v_mfma_f32_16x16x32_bf16 v[52:55], v[164:167], a[128:131], v[52:55]
  ds_write_b128 v13, v[36:39] offset:1088
  s_waitcnt vmcnt(17)
  v_mfma_f32_16x16x32_bf16 v[48:51], v[176:179], a[132:135], v[48:51]
  buffer_load_dwordx4 a[84:87], v2, s[4:7], s63 offen sc1
  v_mfma_f32_16x16x32_bf16 v[52:55], v[180:183], a[132:135], v[52:55]
  ds_write_b128 v13, v[40:43] offset:2176
  s_waitcnt vmcnt(17)
  v_mfma_f32_16x16x32_bf16 v[48:51], v[192:195], a[136:139], v[48:51]
  ds_write_b128 v13, v[44:47] offset:3264
  v_mfma_f32_16x16x32_bf16 v[52:55], v[196:199], a[136:139], v[52:55]
  s_waitcnt vmcnt(16)
  v_mfma_f32_16x16x32_bf16 v[48:51], v[208:211], a[140:143], v[48:51]
  v_mfma_f32_16x16x32_bf16 v[52:55], v[212:215], a[140:143], v[52:55]
  buffer_load_dwordx4 a[88:91], v2, s[4:7], s64 offen sc1
  s_waitcnt vmcnt(16)
  v_mfma_f32_16x16x32_bf16 v[48:51], v[224:227], a[144:147], v[48:51]
  v_mfma_f32_16x16x32_bf16 v[52:55], v[228:231], a[144:147], v[52:55]
  s_waitcnt vmcnt(15)
  v_mfma_f32_16x16x32_bf16 v[48:51], v[240:243], a[148:151], v[48:51]
  v_mfma_f32_16x16x32_bf16 v[52:55], v[244:247], a[148:151], v[52:55]
  s_waitcnt vmcnt(14)
  s_waitcnt lgkmcnt(0)
  s_barrier
  v_mfma_f32_16x16x32_bf16 v[48:51], v[128:131], a[152:155], v[48:51]
  buffer_load_dwordx4 a[92:95], v2, s[4:7], s65 offen sc1
  v_mfma_f32_16x16x32_bf16 v[52:55], v[132:135], a[152:155], v[52:55]
  ds_read_b128 v[64:67], v14 offset:0
  ds_read_b128 v[68:71], v14 offset:16384
  s_waitcnt vmcnt(14)
  v_mfma_f32_16x16x32_bf16 v[48:51], v[144:147], a[156:159], v[48:51]
  ds_read_b128 v[72:75], v14 offset:32768
  ds_read_b128 v[76:79], v14 offset:49152
  v_mfma_f32_16x16x32_bf16 v[52:55], v[148:151], a[156:159], v[52:55]
  ds_read_b128 v[80:83], v16 offset:0
  s_waitcnt lgkmcnt(3)
  s_waitcnt vmcnt(13)
  v_mfma_f32_16x16x32_bf16 v[48:51], a[0:3], a[160:163], v[48:51]
  v_add_f32 v64, v64, v68
  v_add_f32 v65, v65, v69
  v_mfma_f32_16x16x32_bf16 v[52:55], a[4:7], a[160:163], v[52:55]
  buffer_load_dwordx4 a[96:99], v2, s[4:7], s66 offen sc1
  s_waitcnt vmcnt(13)
  v_mfma_f32_16x16x32_bf16 v[48:51], a[16:19], a[164:167], v[48:51]
  v_add_f32 v66, v66, v70
  v_add_f32 v67, v67, v71
  v_mfma_f32_16x16x32_bf16 v[52:55], a[20:23], a[164:167], v[52:55]
  s_waitcnt lgkmcnt(1)
  v_add_f32 v72, v72, v76
  s_waitcnt vmcnt(12)
  v_mfma_f32_16x16x32_bf16 v[48:51], a[32:35], a[168:171], v[48:51]
  v_add_f32 v73, v73, v77
  v_add_f32 v74, v74, v78
  v_mfma_f32_16x16x32_bf16 v[52:55], a[36:39], a[168:171], v[52:55]
  v_add_f32 v75, v75, v79
  s_waitcnt lgkmcnt(0)
  s_waitcnt vmcnt(11)
  v_mfma_f32_16x16x32_bf16 v[48:51], a[48:51], a[172:175], v[48:51]
  buffer_load_dwordx4 a[100:103], v2, s[4:7], s67 offen sc1
  v_mfma_f32_16x16x32_bf16 v[52:55], a[52:55], a[172:175], v[52:55]
  v_add_f32 v64, v64, v80
  v_add_f32 v65, v65, v81
  v_mfma_f32_16x16x32_bf16 v[56:59], a[232:235], a[120:123], 0
  v_mfma_f32_16x16x32_bf16 v[60:63], a[236:239], a[120:123], 0
  v_mfma_f32_16x16x32_bf16 v[56:59], a[248:251], a[124:127], v[56:59]
  v_mfma_f32_16x16x32_bf16 v[60:63], a[252:255], a[124:127], v[60:63]
  v_cmp_u_f32 vcc, v48, v48
  v_mfma_f32_16x16x32_bf16 v[56:59], v[168:171], a[128:131], v[56:59]
  v_mfma_f32_16x16x32_bf16 v[60:63], v[172:175], a[128:131], v[60:63]
  s_nop 2
  s_cbranch_vccnz L_redo_42
L_back_43:
  v_mfma_f32_16x16x32_bf16 v[56:59], v[184:187], a[132:135], v[56:59]
  v_add_f32 v66, v66, v82
  v_add_f32 v67, v67, v83
  v_mfma_f32_16x16x32_bf16 v[60:63], v[188:191], a[132:135], v[60:63]
  v_add_f32 v64, v64, v72
  v_add_f32 v65, v65, v73
  v_mfma_f32_16x16x32_bf16 v[56:59], v[200:203], a[136:139], v[56:59]
  buffer_load_dwordx4 a[104:107], v2, s[4:7], s68 offen sc1
  v_mfma_f32_16x16x32_bf16 v[60:63], v[204:207], a[136:139], v[60:63]
  v_add_f32 v66, v66, v74
  v_add_f32 v67, v67, v75
  v_mfma_f32_16x16x32_bf16 v[56:59], v[216:219], a[140:143], v[56:59]
  v_cvt_pk_bf16_f32 v92, v64, v65
  v_cvt_pk_bf16_f32 v93, v66, v67
  v_mfma_f32_16x16x32_bf16 v[60:63], v[220:223], a[140:143], v[60:63]
  v_mfma_f32_16x16x32_bf16 v[56:59], v[232:235], a[144:147], v[56:59]
  v_mfma_f32_16x16x32_bf16 v[60:63], v[236:239], a[144:147], v[60:63]
  buffer_load_dwordx4 a[108:111], v2, s[4:7], s69 offen sc1
  v_mfma_f32_16x16x32_bf16 v[56:59], v[248:251], a[148:151], v[56:59]
  v_mfma_f32_16x16x32_bf16 v[60:63], v[252:255], a[148:151], v[60:63]
  v_mfma_f32_16x16x32_bf16 v[56:59], v[136:139], a[152:155], v[56:59]
  v_mfma_f32_16x16x32_bf16 v[60:63], v[140:143], a[152:155], v[60:63]
  v_mfma_f32_16x16x32_bf16 v[56:59], v[152:155], a[156:159], v[56:59]
  buffer_load_dwordx4 a[112:115], v2, s[4:7], s70 offen sc1
  v_mfma_f32_16x16x32_bf16 v[60:63], v[156:159], a[156:159], v[60:63]
  v_mfma_f32_16x16x32_bf16 v[56:59], a[8:11], a[160:163], v[56:59]
  v_mfma_f32_16x16x32_bf16 v[60:63], a[12:15], a[160:163], v[60:63]
  v_mfma_f32_16x16x32_bf16 v[56:59], a[24:27], a[164:167], v[56:59]
  v_mfma_f32_16x16x32_bf16 v[60:63], a[28:31], a[164:167], v[60:63]
  buffer_load_dwordx4 a[116:119], v2, s[4:7], s71 offen sc1
  v_mfma_f32_16x16x32_bf16 v[56:59], a[40:43], a[168:171], v[56:59]
  v_mfma_f32_16x16x32_bf16 v[60:63], a[44:47], a[168:171], v[60:63]
  v_mfma_f32_16x16x32_bf16 v[56:59], a[56:59], a[172:175], v[56:59]
  v_mfma_f32_16x16x32_bf16 v[60:63], a[60:63], a[172:175], v[60:63]
  s_add_u32 s55, s50, 344064
  v_add_u32 v2, s55, v4
  s_waitcnt vmcnt(13)
  v_mfma_f32_16x16x32_bf16 v[32:35], a[224:227], a[64:67], 0
  v_mfma_f32_16x16x32_bf16 v[36:39], a[228:231], a[64:67], 0
  s_waitcnt vmcnt(12)
  v_mfma_f32_16x16x32_bf16 v[32:35], a[240:243], a[68:71], v[32:35]
  buffer_load_dwordx4 a[120:123], v2, s[4:7], s58 offen sc1
  v_mfma_f32_16x16x32_bf16 v[36:39], a[244:247], a[68:71], v[36:39]
  s_waitcnt vmcnt(12)
  v_mfma_f32_16x16x32_bf16 v[32:35], v[160:163], a[72:75], v[32:35]
  ds_write_b128 v13, v[48:51] offset:4352
  v_mfma_f32_16x16x32_bf16 v[36:39], v[164:167], a[72:75], v[36:39]
  buffer_load_dwordx4 a[124:127], v2, s[4:7], s59 offen sc1
  s_waitcnt vmcnt(12)
  v_mfma_f32_16x16x32_bf16 v[32:35], v[176:179], a[76:79], v[32:35]
  ds_write_b128 v13, v[52:55] offset:5440
  v_mfma_f32_16x16x32_bf16 v[36:39], v[180:183], a[76:79], v[36:39]
  ds_write_b128 v13, v[56:59] offset:6528
  s_waitcnt vmcnt(11)
  v_mfma_f32_16x16x32_bf16 v[32:35], v[192:195], a[80:83], v[32:35]
  buffer_load_dwordx4 a[128:131], v2, s[4:7], s60 offen sc1
  v_mfma_f32_16x16x32_bf16 v[36:39], v[196:199], a[80:83], v[36:39]
  ds_write_b128 v13, v[60:63] offset:7616
  s_waitcnt vmcnt(11)
  v_mfma_f32_16x16x32_bf16 v[32:35], v[208:211], a[84:87], v[32:35]
  v_mfma_f32_16x16x32_bf16 v[36:39], v[212:215], a[84:87], v[36:39]
  s_waitcnt vmcnt(10)
  v_mfma_f32_16x16x32_bf16 v[32:35], v[224:227], a[88:91], v[32:35]
  buffer_load_dwordx4 a[132:135], v2, s[4:7], s61 offen sc1
  v_mfma_f32_16x16x32_bf16 v[36:39], v[228:231], a[88:91], v[36:39]
  s_waitcnt vmcnt(10)
  v_mfma_f32_16x16x32_bf16 v[32:35], v[240:243], a[92:95], v[32:35]
  v_mfma_f32_16x16x32_bf16 v[36:39], v[244:247], a[92:95], v[36:39]
  buffer_load_dwordx4 a[136:139], v2, s[4:7], s62 offen sc1
  s_waitcnt vmcnt(10)
  s_waitcnt lgkmcnt(0)
  s_barrier
  v_mfma_f32_16x16x32_bf16 v[32:35], v[128:131], a[96:99], v[32:35]
  ds_read_b128 v[64:67], v14 offset:4352
  ds_read_b128 v[68:71], v14 offset:20736
  v_mfma_f32_16x16x32_bf16 v[36:39], v[132:135], a[96:99], v[36:39]
  ds_read_b128 v[72:75], v14 offset:37120
  ds_read_b128 v[76:79], v14 offset:53504
  s_waitcnt vmcnt(9)
  v_mfma_f32_16x16x32_bf16 v[32:35], v[144:147], a[100:103], v[32:35]
  ds_read_b128 v[80:83], v16 offset:4352
  s_waitcnt lgkmcnt(3)
  v_mfma_f32_16x16x32_bf16 v[36:39], v[148:151], a[100:103], v[36:39]
  buffer_load_dwordx4 a[140:143], v2, s[4:7], s63 offen sc1
  s_waitcnt vmcnt(9)
  v_mfma_f32_16x16x32_bf16 v[32:35], a[0:3], a[104:107], v[32:35]
  v_add_f32 v64, v64, v68
  v_add_f32 v65, v65, v69
  v_mfma_f32_16x16x32_bf16 v[36:39], a[4:7], a[104:107], v[36:39]
  v_add_f32 v66, v66, v70
  v_add_f32 v67, v67, v71
  s_waitcnt vmcnt(8)
  v_mfma_f32_16x16x32_bf16 v[32:35], a[16:19], a[108:111], v[32:35]
  buffer_load_dwordx4 a[144:147], v2, s[4:7], s64 offen sc1
  v_mfma_f32_16x16x32_bf16 v[36:39], a[20:23], a[108:111], v[36:39]
  s_waitcnt lgkmcnt(1)
  v_add_f32 v72, v72, v76
  s_waitcnt vmcnt(8)
  v_mfma_f32_16x16x32_bf16 v[32:35], a[32:35], a[112:115], v[32:35]
  v_add_f32 v73, v73, v77
  v_add_f32 v74, v74, v78
  v_mfma_f32_16x16x32_bf16 v[36:39], a[36:39], a[112:115], v[36:39]
  v_add_f32 v75, v75, v79
  s_waitcnt lgkmcnt(0)
  s_waitcnt vmcnt(7)
  v_mfma_f32_16x16x32_bf16 v[32:35], a[48:51], a[116:119], v[32:35]
  buffer_load_dwordx4 a[148:151], v2, s[4:7], s65 offen sc1
  v_mfma_f32_16x16x32_bf16 v[36:39], a[52:55], a[116:119], v[36:39]
  v_add_f32 v64, v64, v80
  v_add_f32 v65, v65, v81
  v_mfma_f32_16x16x32_bf16 v[40:43], a[232:235], a[64:67], 0
  v_mfma_f32_16x16x32_bf16 v[44:47], a[236:239], a[64:67], 0
  v_mfma_f32_16x16x32_bf16 v[40:43], a[248:251], a[68:71], v[40:43]
  v_mfma_f32_16x16x32_bf16 v[44:47], a[252:255], a[68:71], v[44:47]
  v_cmp_u_f32 vcc, v32, v32
  v_mfma_f32_16x16x32_bf16 v[40:43], v[168:171], a[72:75], v[40:43]
  v_mfma_f32_16x16x32_bf16 v[44:47], v[172:175], a[72:75], v[44:47]
  s_nop 2
  s_cbranch_vccnz L_redo_44
L_back_45:
  v_mfma_f32_16x16x32_bf16 v[40:43], v[184:187], a[76:79], v[40:43]
  v_add_f32 v66, v66, v82
  v_add_f32 v67, v67, v83
  v_mfma_f32_16x16x32_bf16 v[44:47], v[188:191], a[76:79], v[44:47]
  buffer_load_dwordx4 a[152:155], v2, s[4:7], s66 offen sc1
  v_mfma_f32_16x16x32_bf16 v[40:43], v[200:203], a[80:83], v[40:43]
  v_add_f32 v64, v64, v72
  v_add_f32 v65, v65, v73
  v_mfma_f32_16x16x32_bf16 v[44:47], v[204:207], a[80:83], v[44:47]
  v_add_f32 v66, v66, v74
  v_add_f32 v67, v67, v75
  v_mfma_f32_16x16x32_bf16 v[40:43], v[216:219], a[84:87], v[40:43]
  buffer_load_dwordx4 a[156:159], v2, s[4:7], s67 offen sc1
  v_mfma_f32_16x16x32_bf16 v[44:47], v[220:223], a[84:87], v[44:47]
  v_cvt_pk_bf16_f32 v94, v64, v65
  v_cvt_pk_bf16_f32 v95, v66, v67
  v_mfma_f32_16x16x32_bf16 v[40:43], v[232:235], a[88:91], v[40:43]
  v_mfma_f32_16x16x32_bf16 v[44:47], v[236:239], a[88:91], v[44:47]
  v_mfma_f32_16x16x32_bf16 v[40:43], v[248:251], a[92:95], v[40:43]
  buffer_load_dwordx4 a[160:163], v2, s[4:7], s68 offen sc1
  v_mfma_f32_16x16x32_bf16 v[44:47], v[252:255], a[92:95], v[44:47]
  v_mfma_f32_16x16x32_bf16 v[40:43], v[136:139], a[96:99], v[40:43]
  v_mfma_f32_16x16x32_bf16 v[44:47], v[140:143], a[96:99], v[44:47]
  buffer_load_dwordx4 a[164:167], v2, s[4:7], s69 offen sc1
  v_mfma_f32_16x16x32_bf16 v[40:43], v[152:155], a[100:103], v[40:43]
  v_mfma_f32_16x16x32_bf16 v[44:47], v[156:159], a[100:103], v[44:47]
  v_mfma_f32_16x16x32_bf16 v[40:43], a[8:11], a[104:107], v[40:43]
  v_mfma_f32_16x16x32_bf16 v[44:47], a[12:15], a[104:107], v[44:47]
  buffer_load_dwordx4 a[168:171], v2, s[4:7], s70 offen sc1
  v_mfma_f32_16x16x32_bf16 v[40:43], a[24:27], a[108:111], v[40:43]
  v_mfma_f32_16x16x32_bf16 v[44:47], a[28:31], a[108:111], v[44:47]
  v_mfma_f32_16x16x32_bf16 v[40:43], a[40:43], a[112:115], v[40:43]
  buffer_load_dwordx4 a[172:175], v2, s[4:7], s71 offen sc1
  v_mfma_f32_16x16x32_bf16 v[44:47], a[44:47], a[112:115], v[44:47]
  v_mfma_f32_16x16x32_bf16 v[40:43], a[56:59], a[116:119], v[40:43]
  v_mfma_f32_16x16x32_bf16 v[44:47], a[60:63], a[116:119], v[44:47]
  s_waitcnt vmcnt(13)
  v_mfma_f32_16x16x32_bf16 v[48:51], a[224:227], a[120:123], 0
  v_mfma_f32_16x16x32_bf16 v[52:55], a[228:231], a[120:123], 0
  s_waitcnt vmcnt(12)
  v_mfma_f32_16x16x32_bf16 v[48:51], a[240:243], a[124:127], v[48:51]
  v_mfma_f32_16x16x32_bf16 v[52:55], a[244:247], a[124:127], v[52:55]
  s_waitcnt vmcnt(11)
  v_mfma_f32_16x16x32_bf16 v[48:51], v[160:163], a[128:131], v[48:51]
  ds_write_b128 v13, v[32:35] offset:0
  v_mfma_f32_16x16x32_bf16 v[52:55], v[164:167], a[128:131], v[52:55]
  ds_write_b128 v13, v[36:39] offset:1088
  s_waitcnt vmcnt(10)
  v_mfma_f32_16x16x32_bf16 v[48:51], v[176:179], a[132:135], v[48:51]
  ds_write_b128 v13, v[40:43] offset:2176
  v_mfma_f32_16x16x32_bf16 v[52:55], v[180:183], a[132:135], v[52:55]
  ds_write_b128 v13, v[44:47] offset:3264
  s_waitcnt vmcnt(9)
  v_mfma_f32_16x16x32_bf16 v[48:51], v[192:195], a[136:139], v[48:51]
  v_mfma_f32_16x16x32_bf16 v[52:55], v[196:199], a[136:139], v[52:55]
  s_waitcnt vmcnt(8)
  v_mfma_f32_16x16x32_bf16 v[48:51], v[208:211], a[140:143], v[48:51]
  v_mfma_f32_16x16x32_bf16 v[52:55], v[212:215], a[140:143], v[52:55]
  s_waitcnt vmcnt(7)
  v_mfma_f32_16x16x32_bf16 v[48:51], v[224:227], a[144:147], v[48:51]
  v_mfma_f32_16x16x32_bf16 v[52:55], v[228:231], a[144:147], v[52:55]
  s_waitcnt vmcnt(6)
  v_mfma_f32_16x16x32_bf16 v[48:51], v[240:243], a[148:151], v[48:51]
  v_mfma_f32_16x16x32_bf16 v[52:55], v[244:247], a[148:151], v[52:55]
  s_waitcnt vmcnt(5)
  s_waitcnt lgkmcnt(0)
  s_barrier
  v_mfma_f32_16x16x32_bf16 v[48:51], v[128:131], a[152:155], v[48:51]
  ds_read_b128 v[64:67], v14 offset:0
  ds_read_b128 v[68:71], v14 offset:16384
  v_mfma_f32_16x16x32_bf16 v[52:55], v[132:135], a[152:155], v[52:55]
  ds_read_b128 v[72:75], v14 offset:32768
  ds_read_b128 v[76:79], v14 offset:49152
  s_waitcnt vmcnt(4)
  v_mfma_f32_16x16x32_bf16 v[48:51], v[144:147], a[156:159], v[48:51]
  ds_read_b128 v[80:83], v16 offset:8704
  s_waitcnt lgkmcnt(3)
  v_mfma_f32_16x16x32_bf16 v[52:55], v[148:151], a[156:159], v[52:55]
  v_add_f32 v64, v64, v68
  v_add_f32 v65, v65, v69
  s_waitcnt vmcnt(3)
  v_mfma_f32_16x16x32_bf16 v[48:51], a[0:3], a[160:163], v[48:51]
  v_add_f32 v66, v66, v70
  v_add_f32 v67, v67, v71
  v_mfma_f32_16x16x32_bf16 v[52:55], a[4:7], a[160:163], v[52:55]
  s_waitcnt lgkmcnt(1)
  v_add_f32 v72, v72, v76
  s_waitcnt vmcnt(2)
  v_mfma_f32_16x16x32_bf16 v[48:51], a[16:19], a[164:167], v[48:51]
  v_add_f32 v73, v73, v77
  v_add_f32 v74, v74, v78
  v_mfma_f32_16x16x32_bf16 v[52:55], a[20:23], a[164:167], v[52:55]
  v_add_f32 v75, v75, v79
  s_waitcnt lgkmcnt(0)
  s_waitcnt vmcnt(1)
  v_mfma_f32_16x16x32_bf16 v[48:51], a[32:35], a[168:171], v[48:51]
  v_add_f32 v64, v64, v80
  v_add_f32 v65, v65, v81
  v_mfma_f32_16x16x32_bf16 v[52:55], a[36:39], a[168:171], v[52:55]
  v_add_f32 v66, v66, v82
  v_add_f32 v67, v67, v83
  s_waitcnt vmcnt(0)
  v_mfma_f32_16x16x32_bf16 v[48:51], a[48:51], a[172:175], v[48:51]
  v_add_f32 v64, v64, v72
  v_add_f32 v65, v65, v73
  v_mfma_f32_16x16x32_bf16 v[52:55], a[52:55], a[172:175], v[52:55]
  v_add_f32 v66, v66, v74
  v_add_f32 v67, v67, v75
  v_mfma_f32_16x16x32_bf16 v[56:59], a[232:235], a[120:123], 0
  v_mfma_f32_16x16x32_bf16 v[60:63], a[236:239], a[120:123], 0
  v_mfma_f32_16x16x32_bf16 v[56:59], a[248:251], a[124:127], v[56:59]
  v_mfma_f32_16x16x32_bf16 v[60:63], a[252:255], a[124:127], v[60:63]
  v_cmp_u_f32 vcc, v48, v48
  v_mfma_f32_16x16x32_bf16 v[56:59], v[168:171], a[128:131], v[56:59]
  v_mfma_f32_16x16x32_bf16 v[60:63], v[172:175], a[128:131], v[60:63]
  s_nop 2
  s_cbranch_vccnz L_redo_46
L_back_47:
  v_mfma_f32_16x16x32_bf16 v[56:59], v[184:187], a[132:135], v[56:59]
  v_cvt_pk_bf16_f32 v96, v64, v65
  v_cvt_pk_bf16_f32 v97, v66, v67
  v_mfma_f32_16x16x32_bf16 v[60:63], v[188:191], a[132:135], v[60:63]
  v_mfma_f32_16x16x32_bf16 v[56:59], v[200:203], a[136:139], v[56:59]
  v_mfma_f32_16x16x32_bf16 v[60:63], v[204:207], a[136:139], v[60:63]
  v_mfma_f32_16x16x32_bf16 v[56:59], v[216:219], a[140:143], v[56:59]
  v_mfma_f32_16x16x32_bf16 v[60:63], v[220:223], a[140:143], v[60:63]
  v_mfma_f32_16x16x32_bf16 v[56:59], v[232:235], a[144:147], v[56:59]
  v_mfma_f32_16x16x32_bf16 v[60:63], v[236:239], a[144:147], v[60:63]
  v_mfma_f32_16x16x32_bf16 v[56:59], v[248:251], a[148:151], v[56:59]
  v_mfma_f32_16x16x32_bf16 v[60:63], v[252:255], a[148:151], v[60:63]
  v_mfma_f32_16x16x32_bf16 v[56:59], v[136:139], a[152:155], v[56:59]
  v_mfma_f32_16x16x32_bf16 v[60:63], v[140:143], a[152:155], v[60:63]
  v_mfma_f32_16x16x32_bf16 v[56:59], v[152:155], a[156:159], v[56:59]
  v_mfma_f32_16x16x32_bf16 v[60:63], v[156:159], a[156:159], v[60:63]
  v_mfma_f32_16x16x32_bf16 v[56:59], a[8:11], a[160:163], v[56:59]
  v_mfma_f32_16x16x32_bf16 v[60:63], a[12:15], a[160:163], v[60:63]
  v_mfma_f32_16x16x32_bf16 v[56:59], a[24:27], a[164:167], v[56:59]
  v_mfma_f32_16x16x32_bf16 v[60:63], a[28:31], a[164:167], v[60:63]
  v_mfma_f32_16x16x32_bf16 v[56:59], a[40:43], a[168:171], v[56:59]
  v_mfma_f32_16x16x32_bf16 v[60:63], a[44:47], a[168:171], v[60:63]
  v_mfma_f32_16x16x32_bf16 v[56:59], a[56:59], a[172:175], v[56:59]
  v_mfma_f32_16x16x32_bf16 v[60:63], a[60:63], a[172:175], v[60:63]
  s_nop 7
  ds_write_b128 v13, v[48:51] offset:4352
  ds_write_b128 v13, v[52:55] offset:5440
  ds_write_b128 v13, v[56:59] offset:6528
  ds_write_b128 v13, v[60:63] offset:7616
  s_waitcnt lgkmcnt(0)
  s_barrier
  s_mov_b32 s80, 0
  buffer_store_dwordx2 v[92:93], v17, s[40:43], s80 offen sc1
  s_mov_b32 s80, 28672
  buffer_store_dwordx2 v[94:95], v17, s[40:43], s80 offen sc1
  s_mov_b32 s80, 57344
  buffer_store_dwordx2 v[96:97], v17, s[40:43], s80 offen sc1
  ds_read_b128 v[64:67], v14 offset:4352
  ds_read_b128 v[68:71], v14 offset:20736
  ds_read_b128 v[72:75], v14 offset:37120
  ds_read_b128 v[76:79], v14 offset:53504
  ds_read_b128 v[80:83], v16 offset:13056
  s_waitcnt lgkmcnt(3)
  v_add_f32 v64, v64, v68
  v_add_f32 v65, v65, v69
  v_add_f32 v66, v66, v70
  v_add_f32 v67, v67, v71
  s_waitcnt lgkmcnt(1)
  v_add_f32 v72, v72, v76
  v_add_f32 v73, v73, v77
  v_add_f32 v74, v74, v78
  v_add_f32 v75, v75, v79
  s_waitcnt lgkmcnt(0)
  v_add_f32 v64, v64, v80
  v_add_f32 v65, v65, v81
  v_add_f32 v66, v66, v82
  v_add_f32 v67, v67, v83
  v_add_f32 v64, v64, v72
  v_add_f32 v65, v65, v73
  v_add_f32 v66, v66, v74
  v_add_f32 v67, v67, v75
  v_cvt_pk_bf16_f32 v98, v64, v65
  v_cvt_pk_bf16_f32 v99, v66, v67
  s_mov_b32 s80, 86016
  buffer_store_dwordx2 v[98:99], v17, s[40:43], s80 offen sc1
  s_waitcnt vmcnt(0) lgkmcnt(0)
  s_endpgm
L_helper:
  s_sub_u32 s86, s2, 224
  s_waitcnt lgkmcnt(0)
  s_mov_b32 s8, s52
  s_mov_b32 s9, s53
  s_mov_b32 s10, 1835008
  s_mov_b32 s11, 0x20000
  s_mov_b32 s40, s70
  s_mov_b32 s41, s71
  s_mov_b32 s42, 1835008
  s_mov_b32 s43, 0x20000
  s_mov_b32 s44, s72
  s_mov_b32 s45, s73
  s_mov_b32 s46, 256
  s_mov_b32 s47, 0x20000
  s_mov_b32 s4, s74
  s_mov_b32 s5, s75
  s_mov_b32 s6, 16777216
  s_mov_b32 s7, 0x20000
  v_mov_b32 v5, 0
  s_lshl_b32 s76, s86, 6
  s_lshl_b32 s77, s3, 4
  s_add_u32 s76, s76, s77
  v_and_b32 v7, 15, v1
  v_add_u32 v8, s76, v7
  v_mul_u32_u24 v6, 896, v8
  v_lshrrev_b32 v4, 4, v1
  v_lshl_add_u32 v6, v4, 4, v6
  buffer_load_dwordx4 v[32:35], v6, s[8:11], 0 offen offset:0
  buffer_load_dwordx4 v[36:39], v6, s[8:11], 0 offen offset:64
  buffer_load_dwordx4 v[40:43], v6, s[8:11], 0 offen offset:128
  buffer_load_dwordx4 v[44:47], v6, s[8:11], 0 offen offset:192
  buffer_load_dwordx4 v[48:51], v6, s[8:11], 0 offen offset:256
  buffer_load_dwordx4 v[52:55], v6, s[8:11], 0 offen offset:320
  buffer_load_dwordx4 v[56:59], v6, s[8:11], 0 offen offset:384
  buffer_load_dwordx4 v[60:63], v6, s[8:11], 0 offen offset:448
  buffer_load_dwordx4 v[64:67], v6, s[8:11], 0 offen offset:512
  buffer_load_dwordx4 v[68:71], v6, s[8:11], 0 offen offset:576
  buffer_load_dwordx4 v[72:75], v6, s[8:11], 0 offen offset:640
  buffer_load_dwordx4 v[76:79], v6, s[8:11], 0 offen offset:704
  buffer_load_dwordx4 v[80:83], v6, s[8:11], 0 offen offset:768
  buffer_load_dwordx4 v[84:87], v6, s[8:11], 0 offen offset:832
  s_cmp_eq_u32 s3, 0
  s_cbranch_scc0 L_hz_48
  s_lshl_b32 s76, s86, 8
  s_add_u32 s76, s76, 14712832
  v_lshl_add_u32 v7, v1, 2, s76
  buffer_store_dword v5, v7, s[4:7], 0 offen sc1
L_hz_48:
  v_mov_b32 v16, 0x3f803f80
  v_mov_b32 v17, 0x3f803f80
  v_mov_b32 v18, 0x3f803f80
  v_mov_b32 v19, 0x3f803f80
  s_waitcnt vmcnt(0)
  v_mfma_f32_16x16x32_bf16 v[20:23], v[32:35], v[32:35], 0
  v_mfma_f32_16x16x32_bf16 v[24:27], v[16:19], v[32:35], 0
  v_mfma_f32_16x16x32_bf16 v[20:23], v[36:39], v[36:39], v[20:23]
  v_mfma_f32_16x16x32_bf16 v[24:27], v[16:19], v[36:39], v[24:27]
  v_mfma_f32_16x16x32_bf16 v[20:23], v[40:43], v[40:43], v[20:23]
  v_mfma_f32_16x16x32_bf16 v[24:27], v[16:19], v[40:43], v[24:27]
  v_mfma_f32_16x16x32_bf16 v[20:23], v[44:47], v[44:47], v[20:23]
  v_mfma_f32_16x16x32_bf16 v[24:27], v[16:19], v[44:47], v[24:27]
  v_mfma_f32_16x16x32_bf16 v[20:23], v[48:51], v[48:51], v[20:23]
  v_mfma_f32_16x16x32_bf16 v[24:27], v[16:19], v[48:51], v[24:27]
  v_mfma_f32_16x16x32_bf16 v[20:23], v[52:55], v[52:55], v[20:23]
  v_mfma_f32_16x16x32_bf16 v[24:27], v[16:19], v[52:55], v[24:27]
  v_mfma_f32_16x16x32_bf16 v[20:23], v[56:59], v[56:59], v[20:23]
  v_mfma_f32_16x16x32_bf16 v[24:27], v[16:19], v[56:59], v[24:27]
  v_mfma_f32_16x16x32_bf16 v[20:23], v[60:63], v[60:63], v[20:23]
  v_mfma_f32_16x16x32_bf16 v[24:27], v[16:19], v[60:63], v[24:27]
  v_mfma_f32_16x16x32_bf16 v[20:23], v[64:67], v[64:67], v[20:23]
  v_mfma_f32_16x16x32_bf16 v[24:27], v[16:19], v[64:67], v[24:27]
  v_mfma_f32_16x16x32_bf16 v[20:23], v[68:71], v[68:71], v[20:23]
  v_mfma_f32_16x16x32_bf16 v[24:27], v[16:19], v[68:71], v[24:27]
  v_mfma_f32_16x16x32_bf16 v[20:23], v[72:75], v[72:75], v[20:23]
  v_mfma_f32_16x16x32_bf16 v[24:27], v[16:19], v[72:75], v[24:27]
  v_mfma_f32_16x16x32_bf16 v[20:23], v[76:79], v[76:79], v[20:23]
  v_mfma_f32_16x16x32_bf16 v[24:27], v[16:19], v[76:79], v[24:27]
  v_mfma_f32_16x16x32_bf16 v[20:23], v[80:83], v[80:83], v[20:23]
  v_mfma_f32_16x16x32_bf16 v[24:27], v[16:19], v[80:83], v[24:27]
  v_mfma_f32_16x16x32_bf16 v[20:23], v[84:87], v[84:87], v[20:23]
  v_mfma_f32_16x16x32_bf16 v[24:27], v[16:19], v[84:87], v[24:27]
  s_nop 7
  s_mov_b32 s82, 0x22222222
  s_mov_b32 s83, 0x22222222
  v_cndmask_b32 v11, v20, v21, s[82:83]
  s_mov_b32 s82, 0x44444444
  s_mov_b32 s83, 0x44444444
  v_cndmask_b32 v11, v11, v22, s[82:83]
  s_mov_b32 s82, 0x88888888
  s_mov_b32 s83, 0x88888888
  v_cndmask_b32 v11, v11, v23, s[82:83]
  s_mov_b32 s82, 0x3b124925
  v_mul_f32 v12, s82, v24
  v_mul_f32 v11, s82, v11
  v_fma_f32 v11, -v12, v12, v11
  v_max_f32 v11, 0, v11
  v_cvt_pk_bf16_f32 v11, v11, v12
  v_and_b32 v12, 0xffff0000, v11
  v_lshlrev_b32 v11, 16, v11
  v_add_f32 v11, 0x3727c5ac, v11
  v_cvt_pk_bf16_f32 v11, v11, v11
  v_lshlrev_b32 v11, 16, v11
  v_sqrt_f32 v11, v11
  s_nop 0
  v_cvt_pk_bf16_f32 v11, v11, v11
  v_lshlrev_b32 v11, 16, v11
  v_rcp_f32 v28, v11
  s_nop 0
  v_mul_f32 v29, -v12, v28
  v_lshlrev_b32 v7, 2, v8
  s_mov_b32 s80, 14680064
  s_mov_b32 s81, 14688256
  s_mov_b32 exec_lo, 0x00f0000f
  s_mov_b32 exec_hi, 0xf0000f00
  buffer_store_dword v28, v7, s[4:7], s80 offen sc1
  buffer_store_dword v29, v7, s[4:7], s81 offen sc1
  s_mov_b64 exec, -1
  s_mov_b32 s92, 40000
L_go_49:
  buffer_load_dword v30, v5, s[44:47], 0 offen offset:0 sc1
  s_waitcnt vmcnt(0)
  v_cmp_eq_u32 vcc, 0, v30
  s_nop 4
  s_cbranch_vccz L_god_50
  s_sub_u32 s92, s92, 1
  s_cmp_lg_u32 s92, 0
  s_cbranch_scc1 L_go_49
L_god_50:
  s_barrier
  v_lshlrev_b32 v7, 8, v1
  v_add_u32 v7, 14759936, v7
  v_mov_b32 v4, 1
  s_cmp_eq_u32 s3, 0
  s_cbranch_scc0 L_sig_51
  s_mov_b64 exec, 255
  buffer_atomic_add v4, v7, s[4:7], 0 offen sc1
  s_mov_b64 exec, -1
L_sig_51:
  v_mov_b32 v40, -1
  v_mov_b32 v41, -1
  v_mov_b32 v42, -1
  v_mov_b32 v43, -1
  v_lshlrev_b32 v9, 4, v1
  s_mul_i32 s76, s86, 57344
  s_mul_i32 s77, s3, 14336
  s_add_u32 s76, s76, s77
  s_add_u32 s76, s76, 4194304
  buffer_store_dwordx4 v[40:43], v9, s[4:7], s76 offen offset:0 sc1
  buffer_store_dwordx4 v[40:43], v9, s[4:7], s76 offen offset:1024 sc1
  buffer_store_dwordx4 v[40:43], v9, s[4:7], s76 offen offset:2048 sc1
  buffer_store_dwordx4 v[40:43], v9, s[4:7], s76 offen offset:3072 sc1
  s_add_u32 s76, s76, 4096
  buffer_store_dwordx4 v[40:43], v9, s[4:7], s76 offen offset:0 sc1
  buffer_store_dwordx4 v[40:43], v9, s[4:7], s76 offen offset:1024 sc1
  buffer_store_dwordx4 v[40:43], v9, s[4:7], s76 offen offset:2048 sc1
  buffer_store_dwordx4 v[40:43], v9, s[4:7], s76 offen offset:3072 sc1
  s_add_u32 s76, s76, 4096
  buffer_store_dwordx4 v[40:43], v9, s[4:7], s76 offen offset:0 sc1
  buffer_store_dwordx4 v[40:43], v9, s[4:7], s76 offen offset:1024 sc1
  buffer_store_dwordx4 v[40:43], v9, s[4:7], s76 offen offset:2048 sc1
  buffer_store_dwordx4 v[40:43], v9, s[4:7], s76 offen offset:3072 sc1
  s_add_u32 s76, s76, 4096
  buffer_store_dwordx4 v[40:43], v9, s[4:7], s76 offen offset:0 sc1
  buffer_store_dwordx4 v[40:43], v9, s[4:7], s76 offen offset:1024 sc1
  s_waitcnt vmcnt(0)
  s_barrier
  v_lshlrev_b32 v7, 8, v1
  v_add_u32 v7, 14764032, v7
  v_mov_b32 v4, 1
  s_cmp_eq_u32 s3, 0
  s_cbranch_scc0 L_sig_52
  s_mov_b64 exec, 255
  buffer_atomic_add v4, v7, s[4:7], 0 offen sc1
  s_mov_b64 exec, -1
L_sig_52:
  s_mul_i32 s76, s86, 229376
  s_mul_i32 s77, s3, 57344
  s_add_u32 s76, s76, s77
  s_add_u32 s76, s76, 6291456
  buffer_store_dwordx4 v[40:43], v9, s[4:7], s76 offen offset:0 sc1
  buffer_store_dwordx4 v[40:43], v9, s[4:7], s76 offen offset:1024 sc1
  buffer_store_dwordx4 v[40:43], v9, s[4:7], s76 offen offset:2048 sc1
  buffer_store_dwordx4 v[40:43], v9, s[4:7], s76 offen offset:3072 sc1
  s_add_u32 s76, s76, 4096
  s_waitcnt vmcnt(8)
  buffer_store_dwordx4 v[40:43], v9, s[4:7], s76 offen offset:0 sc1
  buffer_store_dwordx4 v[40:43], v9, s[4:7], s76 offen offset:1024 sc1
  buffer_store_dwordx4 v[40:43], v9, s[4:7], s76 offen offset:2048 sc1
  buffer_store_dwordx4 v[40:43], v9, s[4:7], s76 offen offset:3072 sc1
  s_add_u32 s76, s76, 4096
  s_waitcnt vmcnt(8)
  buffer_store_dwordx4 v[40:43], v9, s[4:7], s76 offen offset:0 sc1
  buffer_store_dwordx4 v[40:43], v9, s[4:7], s76 offen offset:1024 sc1
  buffer_store_dwordx4 v[40:43], v9, s[4:7], s76 offen offset:2048 sc1
  buffer_store_dwordx4 v[40:43], v9, s[4:7], s76 offen offset:3072 sc1
  s_add_u32 s76, s76, 4096
  s_waitcnt vmcnt(8)
  buffer_store_dwordx4 v[40:43], v9, s[4:7], s76 offen offset:0 sc1
  buffer_store_dwordx4 v[40:43], v9, s[4:7], s76 offen offset:1024 sc1
  buffer_store_dwordx4 v[40:43], v9, s[4:7], s76 offen offset:2048 sc1
  buffer_store_dwordx4 v[40:43], v9, s[4:7], s76 offen offset:3072 sc1
  s_add_u32 s76, s76, 4096
  s_waitcnt vmcnt(8)
  buffer_store_dwordx4 v[40:43], v9, s[4:7], s76 offen offset:0 sc1
  buffer_store_dwordx4 v[40:43], v9, s[4:7], s76 offen offset:1024 sc1
  buffer_store_dwordx4 v[40:43], v9, s[4:7], s76 offen offset:2048 sc1
  buffer_store_dwordx4 v[40:43], v9, s[4:7], s76 offen offset:3072 sc1
  s_add_u32 s76, s76, 4096
  s_waitcnt vmcnt(8)
  buffer_store_dwordx4 v[40:43], v9, s[4:7], s76 offen offset:0 sc1
  buffer_store_dwordx4 v[40:43], v9, s[4:7], s76 offen offset:1024 sc1
  buffer_store_dwordx4 v[40:43], v9, s[4:7], s76 offen offset:2048 sc1
  buffer_store_dwordx4 v[40:43], v9, s[4:7], s76 offen offset:3072 sc1
  s_add_u32 s76, s76, 4096
  s_waitcnt vmcnt(8)
  buffer_store_dwordx4 v[40:43], v9, s[4:7], s76 offen offset:0 sc1
  buffer_store_dwordx4 v[40:43], v9, s[4:7], s76 offen offset:1024 sc1
  buffer_store_dwordx4 v[40:43], v9, s[4:7], s76 offen offset:2048 sc1
  buffer_store_dwordx4 v[40:43], v9, s[4:7], s76 offen offset:3072 sc1
  s_add_u32 s76, s76, 4096
  s_waitcnt vmcnt(8)
  buffer_store_dwordx4 v[40:43], v9, s[4:7], s76 offen offset:0 sc1
  buffer_store_dwordx4 v[40:43], v9, s[4:7], s76 offen offset:1024 sc1
  buffer_store_dwordx4 v[40:43], v9, s[4:7], s76 offen offset:2048 sc1
  buffer_store_dwordx4 v[40:43], v9, s[4:7], s76 offen offset:3072 sc1
  s_add_u32 s76, s76, 4096
  s_waitcnt vmcnt(8)
  buffer_store_dwordx4 v[40:43], v9, s[4:7], s76 offen offset:0 sc1
  buffer_store_dwordx4 v[40:43], v9, s[4:7], s76 offen offset:1024 sc1
  buffer_store_dwordx4 v[40:43], v9, s[4:7], s76 offen offset:2048 sc1
  buffer_store_dwordx4 v[40:43], v9, s[4:7], s76 offen offset:3072 sc1
  s_add_u32 s76, s76, 4096
  s_waitcnt vmcnt(8)
  buffer_store_dwordx4 v[40:43], v9, s[4:7], s76 offen offset:0 sc1
  buffer_store_dwordx4 v[40:43], v9, s[4:7], s76 offen offset:1024 sc1
  buffer_store_dwordx4 v[40:43], v9, s[4:7], s76 offen offset:2048 sc1
  buffer_store_dwordx4 v[40:43], v9, s[4:7], s76 offen offset:3072 sc1
  s_add_u32 s76, s76, 4096
  s_waitcnt vmcnt(8)
  buffer_store_dwordx4 v[40:43], v9, s[4:7], s76 offen offset:0 sc1
  buffer_store_dwordx4 v[40:43], v9, s[4:7], s76 offen offset:1024 sc1
  buffer_store_dwordx4 v[40:43], v9, s[4:7], s76 offen offset:2048 sc1
  buffer_store_dwordx4 v[40:43], v9, s[4:7], s76 offen offset:3072 sc1
  s_add_u32 s76, s76, 4096
  s_waitcnt vmcnt(8)
  buffer_store_dwordx4 v[40:43], v9, s[4:7], s76 offen offset:0 sc1
  buffer_store_dwordx4 v[40:43], v9, s[4:7], s76 offen offset:1024 sc1
  buffer_store_dwordx4 v[40:43], v9, s[4:7], s76 offen offset:2048 sc1
  buffer_store_dwordx4 v[40:43], v9, s[4:7], s76 offen offset:3072 sc1
  s_add_u32 s76, s76, 4096
  s_waitcnt vmcnt(8)
  buffer_store_dwordx4 v[40:43], v9, s[4:7], s76 offen offset:0 sc1
  buffer_store_dwordx4 v[40:43], v9, s[4:7], s76 offen offset:1024 sc1
  buffer_store_dwordx4 v[40:43], v9, s[4:7], s76 offen offset:2048 sc1
  buffer_store_dwordx4 v[40:43], v9, s[4:7], s76 offen offset:3072 sc1
  s_add_u32 s76, s76, 4096
  s_waitcnt vmcnt(8)
  buffer_store_dwordx4 v[40:43], v9, s[4:7], s76 offen offset:0 sc1
  buffer_store_dwordx4 v[40:43], v9, s[4:7], s76 offen offset:1024 sc1
  buffer_store_dwordx4 v[40:43], v9, s[4:7], s76 offen offset:2048 sc1
  buffer_store_dwordx4 v[40:43], v9, s[4:7], s76 offen offset:3072 sc1
  s_waitcnt vmcnt(0)
  s_barrier
  v_lshlrev_b32 v7, 8, v1
  v_add_u32 v7, 14761984, v7
  v_mov_b32 v4, 1
  s_cmp_eq_u32 s3, 0
  s_cbranch_scc0 L_sig_53
  s_mov_b64 exec, 255
  buffer_atomic_add v4, v7, s[4:7], 0 offen sc1
  s_mov_b64 exec, -1
L_sig_53:
  s_and_b32 s76, s2, 7
  s_lshl_b32 s76, s76, 8
  s_add_u32 s76, s76, 14764032
  v_mov_b32 v7, s76
  v_mov_b32 v4, 32
  s_cmp_eq_u32 s3, 0
  s_cbranch_scc0 L_pskip_54
  s_mov_b32 s92, 40000
L_ploop_55:
  buffer_load_dword v30, v7, s[4:7], 0 offen sc1
  s_waitcnt vmcnt(0)
  v_cmp_lt_u32 vcc, v30, v4
  s_nop 4
  s_cbranch_vccz L_pdone_56
  s_sub_u32 s92, s92, 1
  s_cmp_lg_u32 s92, 0
  s_cbranch_scc0 L_pdone_56
  s_sleep 1
  s_branch L_ploop_55
L_pdone_56:
L_pskip_54:
  s_barrier
  s_lshr_b32 s76, s86, 1
  s_lshl_b32 s76, s76, 2
  s_and_b32 s77, s86, 1
  s_add_u32 s76, s76, s77
  s_mov_b32 s51, s76
  v_lshlrev_b32 v9, 4, v1
  s_mul_i32 s79, s3, 7168
  v_add_u32 v92, s79, v9
  v_lshrrev_b32 v7, 4, v1
  v_bfe_u32 v4, v1, 2, 2
  v_lshl_add_u32 v7, v7, 3, v4
  v_lshlrev_b32 v7, 6, v7
  v_and_b32 v4, 3, v1
  v_lshl_add_u32 v10, v4, 3, v7
  s_lshr_b32 s80, s3, 1
  s_mul_i32 s80, s80, 14336
  s_and_b32 s81, s3, 1
  s_lshl_b32 s81, s81, 5
  s_add_u32 s80, s80, s81
  v_add_u32 v10, s80, v10
  s_lshl_b32 s80, s3, 9
  s_add_u32 s80, s80, 57344
  v_lshl_add_u32 v14, v1, 3, s80
  s_lshl_b32 s80, s76, 5
  s_and_b32 s81, s3, 1
  s_lshl_b32 s81, s81, 4
  s_add_u32 s80, s80, s81
  s_lshl_b32 s80, s80, 2
  s_add_u32 s80, s80, 14712832
  v_and_b32 v7, 15, v1
  v_lshl_add_u32 v15, v7, 2, s80
  s_add_u32 s56, s51, 0
  s_mul_i32 s56, s56, 28672
  s_mul_i32 s57, s3, 7168
  s_add_u32 s56, s56, s57
  s_add_u32 s56, s56, 4194304
  s_add_u32 m0, s57, 0
  s_nop 0
  buffer_load_dwordx4 v9, s[4:7], s56 offen offset:0 sc1 lds
  buffer_load_dwordx4 v9, s[4:7], s56 offen offset:1024 sc1 lds
  buffer_load_dwordx4 v9, s[4:7], s56 offen offset:2048 sc1 lds
  buffer_load_dwordx4 v9, s[4:7], s56 offen offset:3072 sc1 lds
  s_add_u32 s56, s56, 4096
  s_add_u32 m0, s57, 4096
  s_nop 0
  buffer_load_dwordx4 v9, s[4:7], s56 offen offset:0 sc1 lds
  buffer_load_dwordx4 v9, s[4:7], s56 offen offset:1024 sc1 lds
  buffer_load_dwordx4 v9, s[4:7], s56 offen offset:2048 sc1 lds
  s_waitcnt vmcnt(0)
  ds_read_b128 v[64:67], v92 offset:0
  ds_read_b128 v[68:71], v92 offset:1024
  ds_read_b128 v[72:75], v92 offset:2048
  ds_read_b128 v[76:79], v92 offset:3072
  ds_read_b128 v[80:83], v92 offset:4096
  ds_read_b128 v[84:87], v92 offset:5120
  ds_read_b128 v[88:91], v92 offset:6144
  s_waitcnt lgkmcnt(0)
  v_max3_u32 v64, v64, v65, v66
  v_max3_u32 v64, v64, v67, v68
  v_max3_u32 v64, v64, v69, v70
  v_max3_u32 v64, v64, v71, v72
  v_max3_u32 v64, v64, v73, v74
  v_max3_u32 v64, v64, v75, v76
  v_max3_u32 v64, v64, v77, v78
  v_max3_u32 v64, v64, v79, v80
  v_max3_u32 v64, v64, v81, v82
  v_max3_u32 v64, v64, v83, v84
  v_max3_u32 v64, v64, v85, v86
  v_max3_u32 v64, v64, v87, v88
  v_max3_u32 v64, v64, v89, v90
  v_max_u32 v64, v64, v91
  v_cmp_eq_u32 vcc, -1, v64
  s_nop 4
  s_cbranch_vccnz L_mk_57
L_mkb_58:
  s_barrier
  ds_read_b64_tr_b16 v[32:33], v10 offset:0
  ds_read_b64_tr_b16 v[34:35], v10 offset:256
  ds_read_b64_tr_b16 v[36:37], v10 offset:2048
  ds_read_b64_tr_b16 v[38:39], v10 offset:2304
  ds_read_b64_tr_b16 v[40:41], v10 offset:4096
  ds_read_b64_tr_b16 v[42:43], v10 offset:4352
  ds_read_b64_tr_b16 v[44:45], v10 offset:6144
  ds_read_b64_tr_b16 v[46:47], v10 offset:6400
  ds_read_b64_tr_b16 v[48:49], v10 offset:8192
  ds_read_b64_tr_b16 v[50:51], v10 offset:8448
  ds_read_b64_tr_b16 v[52:53], v10 offset:10240
  ds_read_b64_tr_b16 v[54:55], v10 offset:10496
  ds_read_b64_tr_b16 v[56:57], v10 offset:12288
  ds_read_b64_tr_b16 v[58:59], v10 offset:12544
  s_waitcnt lgkmcnt(12)
  v_mfma_f32_16x16x32_bf16 v[20:23], v[32:35], v[32:35], 0
  v_mfma_f32_16x16x32_bf16 v[24:27], v[16:19], v[32:35], 0
  s_waitcnt lgkmcnt(10)
  v_mfma_f32_16x16x32_bf16 v[20:23], v[36:39], v[36:39], v[20:23]
  v_mfma_f32_16x16x32_bf16 v[24:27], v[16:19], v[36:39], v[24:27]
  s_waitcnt lgkmcnt(8)
  v_mfma_f32_16x16x32_bf16 v[20:23], v[40:43], v[40:43], v[20:23]
  v_mfma_f32_16x16x32_bf16 v[24:27], v[16:19], v[40:43], v[24:27]
  s_waitcnt lgkmcnt(6)
  v_mfma_f32_16x16x32_bf16 v[20:23], v[44:47], v[44:47], v[20:23]
  v_mfma_f32_16x16x32_bf16 v[24:27], v[16:19], v[44:47], v[24:27]
  s_waitcnt lgkmcnt(4)
  v_mfma_f32_16x16x32_bf16 v[20:23], v[48:51], v[48:51], v[20:23]
  v_mfma_f32_16x16x32_bf16 v[24:27], v[16:19], v[48:51], v[24:27]
  s_waitcnt lgkmcnt(2)
  v_mfma_f32_16x16x32_bf16 v[20:23], v[52:55], v[52:55], v[20:23]
  v_mfma_f32_16x16x32_bf16 v[24:27], v[16:19], v[52:55], v[24:27]
  s_waitcnt lgkmcnt(0)
  v_mfma_f32_16x16x32_bf16 v[20:23], v[56:59], v[56:59], v[20:23]
  v_mfma_f32_16x16x32_bf16 v[24:27], v[16:19], v[56:59], v[24:27]
  s_nop 7
  s_mov_b32 s82, 0x22222222
  s_mov_b32 s83, 0x22222222
  v_cndmask_b32 v11, v20, v21, s[82:83]
  s_mov_b32 s82, 0x44444444
  s_mov_b32 s83, 0x44444444
  v_cndmask_b32 v11, v11, v22, s[82:83]
  s_mov_b32 s82, 0x88888888
  s_mov_b32 s83, 0x88888888
  v_cndmask_b32 v11, v11, v23, s[82:83]
  v_mov_b32 v12, v24
  v_mov_b32 v60, v11
  v_mov_b32 v61, v12
  ds_write_b64 v14, v[60:61] offset:0
  s_waitcnt lgkmcnt(0)
  s_barrier
  v_xor_b32 v13, 1024, v14
  ds_read_b64 v[62:63], v13 offset:0
  s_waitcnt lgkmcnt(0)
  v_add_f32 v11, v60, v62
  v_add_f32 v24, v61, v63
  s_mov_b32 s82, 0x3b124925
  v_mul_f32 v12, s82, v24
  v_mul_f32 v11, s82, v11
  v_fma_f32 v11, -v12, v12, v11
  v_max_f32 v11, 0, v11
  v_cvt_pk_bf16_f32 v11, v11, v12
  v_and_b32 v12, 0xffff0000, v11
  v_lshlrev_b32 v11, 16, v11
  v_add_f32 v11, 0x3727c5ac, v11
  v_cvt_pk_bf16_f32 v11, v11, v11
  v_lshlrev_b32 v11, 16, v11
  v_sqrt_f32 v11, v11
  s_nop 0
  v_cvt_pk_bf16_f32 v11, v11, v11
  v_lshrrev_b32 v13, 16, v12
  v_and_b32 v11, 0xffff0000, v11
  v_or_b32 v28, v11, v13
  s_cmp_lt_u32 s3, 2
  s_cbranch_scc0 L_hs_59
  s_mov_b32 exec_lo, 0x00f0000f
  s_mov_b32 exec_hi, 0xf0000f00
  buffer_store_dword v28, v15, s[4:7], 0 offen offset:0 sc1
  s_mov_b64 exec, -1
L_hs_59:
  s_add_u32 s56, s51, 2
  s_mul_i32 s56, s56, 28672
  s_mul_i32 s57, s3, 7168
  s_add_u32 s56, s56, s57
  s_add_u32 s56, s56, 4194304
  s_add_u32 m0, s57, 28672
  s_nop 0
  buffer_load_dwordx4 v9, s[4:7], s56 offen offset:0 sc1 lds
  buffer_load_dwordx4 v9, s[4:7], s56 offen offset:1024 sc1 lds
  buffer_load_dwordx4 v9, s[4:7], s56 offen offset:2048 sc1 lds
  buffer_load_dwordx4 v9, s[4:7], s56 offen offset:3072 sc1 lds
  s_add_u32 s56, s56, 4096
  s_add_u32 m0, s57, 32768
  s_nop 0
  buffer_load_dwordx4 v9, s[4:7], s56 offen offset:0 sc1 lds
  buffer_load_dwordx4 v9, s[4:7], s56 offen offset:1024 sc1 lds
  buffer_load_dwordx4 v9, s[4:7], s56 offen offset:2048 sc1 lds
  s_waitcnt vmcnt(0)
  ds_read_b128 v[64:67], v92 offset:28672
  ds_read_b128 v[68:71], v92 offset:29696
  ds_read_b128 v[72:75], v92 offset:30720
  ds_read_b128 v[76:79], v92 offset:31744
  ds_read_b128 v[80:83], v92 offset:32768
  ds_read_b128 v[84:87], v92 offset:33792
  ds_read_b128 v[88:91], v92 offset:34816
  s_waitcnt lgkmcnt(0)
  v_max3_u32 v64, v64, v65, v66
  v_max3_u32 v64, v64, v67, v68
  v_max3_u32 v64, v64, v69, v70
  v_max3_u32 v64, v64, v71, v72
  v_max3_u32 v64, v64, v73, v74
  v_max3_u32 v64, v64, v75, v76
  v_max3_u32 v64, v64, v77, v78
  v_max3_u32 v64, v64, v79, v80
  v_max3_u32 v64, v64, v81, v82
  v_max3_u32 v64, v64, v83, v84
  v_max3_u32 v64, v64, v85, v86
  v_max3_u32 v64, v64, v87, v88
  v_max3_u32 v64, v64, v89, v90
  v_max_u32 v64, v64, v91
  v_cmp_eq_u32 vcc, -1, v64
  s_nop 4
  s_cbranch_vccnz L_mk_60
L_mkb_61:
  s_barrier
  ds_read_b64_tr_b16 v[32:33], v10 offset:28672
  ds_read_b64_tr_b16 v[34:35], v10 offset:28928
  ds_read_b64_tr_b16 v[36:37], v10 offset:30720
  ds_read_b64_tr_b16 v[38:39], v10 offset:30976
  ds_read_b64_tr_b16 v[40:41], v10 offset:32768
  ds_read_b64_tr_b16 v[42:43], v10 offset:33024
  ds_read_b64_tr_b16 v[44:45], v10 offset:34816
  ds_read_b64_tr_b16 v[46:47], v10 offset:35072
  ds_read_b64_tr_b16 v[48:49], v10 offset:36864
  ds_read_b64_tr_b16 v[50:51], v10 offset:37120
  ds_read_b64_tr_b16 v[52:53], v10 offset:38912
  ds_read_b64_tr_b16 v[54:55], v10 offset:39168
  ds_read_b64_tr_b16 v[56:57], v10 offset:40960
  ds_read_b64_tr_b16 v[58:59], v10 offset:41216
  s_waitcnt lgkmcnt(12)
  v_mfma_f32_16x16x32_bf16 v[20:23], v[32:35], v[32:35], 0
  v_mfma_f32_16x16x32_bf16 v[24:27], v[16:19], v[32:35], 0
  s_waitcnt lgkmcnt(10)
  v_mfma_f32_16x16x32_bf16 v[20:23], v[36:39], v[36:39], v[20:23]
  v_mfma_f32_16x16x32_bf16 v[24:27], v[16:19], v[36:39], v[24:27]
  s_waitcnt lgkmcnt(8)
  v_mfma_f32_16x16x32_bf16 v[20:23], v[40:43], v[40:43], v[20:23]
  v_mfma_f32_16x16x32_bf16 v[24:27], v[16:19], v[40:43], v[24:27]
  s_waitcnt lgkmcnt(6)
  v_mfma_f32_16x16x32_bf16 v[20:23], v[44:47], v[44:47], v[20:23]
  v_mfma_f32_16x16x32_bf16 v[24:27], v[16:19], v[44:47], v[24:27]
  s_waitcnt lgkmcnt(4)
  v_mfma_f32_16x16x32_bf16 v[20:23], v[48:51], v[48:51], v[20:23]
  v_mfma_f32_16x16x32_bf16 v[24:27], v[16:19], v[48:51], v[24:27]
  s_waitcnt lgkmcnt(2)
  v_mfma_f32_16x16x32_bf16 v[20:23], v[52:55], v[52:55], v[20:23]
  v_mfma_f32_16x16x32_bf16 v[24:27], v[16:19], v[52:55], v[24:27]
  s_waitcnt lgkmcnt(0)
  v_mfma_f32_16x16x32_bf16 v[20:23], v[56:59], v[56:59], v[20:23]
  v_mfma_f32_16x16x32_bf16 v[24:27], v[16:19], v[56:59], v[24:27]
  s_nop 7
  s_mov_b32 s82, 0x22222222
  s_mov_b32 s83, 0x22222222
  v_cndmask_b32 v11, v20, v21, s[82:83]
  s_mov_b32 s82, 0x44444444
  s_mov_b32 s83, 0x44444444
  v_cndmask_b32 v11, v11, v22, s[82:83]
  s_mov_b32 s82, 0x88888888
  s_mov_b32 s83, 0x88888888
  v_cndmask_b32 v11, v11, v23, s[82:83]
  v_mov_b32 v12, v24
  v_mov_b32 v60, v11
  v_mov_b32 v61, v12
  ds_write_b64 v14, v[60:61] offset:2048
  s_waitcnt lgkmcnt(0)
  s_barrier
  v_xor_b32 v13, 1024, v14
  ds_read_b64 v[62:63], v13 offset:2048
  s_waitcnt lgkmcnt(0)
  v_add_f32 v11, v60, v62
  v_add_f32 v24, v61, v63
  s_mov_b32 s82, 0x3b124925
  v_mul_f32 v12, s82, v24
  v_mul_f32 v11, s82, v11
  v_fma_f32 v11, -v12, v12, v11
  v_max_f32 v11, 0, v11
  v_cvt_pk_bf16_f32 v11, v11, v12
  v_and_b32 v12, 0xffff0000, v11
  v_lshlrev_b32 v11, 16, v11
  v_add_f32 v11, 0x3727c5ac, v11
  v_cvt_pk_bf16_f32 v11, v11, v11
  v_lshlrev_b32 v11, 16, v11
  v_sqrt_f32 v11, v11
  s_nop 0
  v_cvt_pk_bf16_f32 v11, v11, v11
  v_lshrrev_b32 v13, 16, v12
  v_and_b32 v11, 0xffff0000, v11
  v_or_b32 v28, v11, v13
  s_cmp_lt_u32 s3, 2
  s_cbranch_scc0 L_hs_62
  s_mov_b32 exec_lo, 0x00f0000f
  s_mov_b32 exec_hi, 0xf0000f00
  buffer_store_dword v28, v15, s[4:7], 0 offen offset:256 sc1
  s_mov_b64 exec, -1
L_hs_62:
  s_cmp_eq_u32 s86, 0
  s_cbranch_scc0 L_clr_63
  s_cmp_eq_u32 s3, 0
  s_cbranch_scc0 L_clr_63
  v_mov_b32 v5, 0
  s_mov_b64 exec, 1
  buffer_store_dword v5, v5, s[44:47], 0 offen offset:0 sc1
  s_mov_b64 exec, -1
L_clr_63:
  s_waitcnt vmcnt(0) lgkmcnt(0)
  s_endpgm
L_redo_40:
  s_add_u32 s55, s50, 0
  v_add_u32 v126, s55, v4
  s_mov_b32 s92, 40000
L_rl_64:
  buffer_load_dwordx4 a[64:67], v126, s[4:7], s58 offen sc1
  buffer_load_dwordx4 a[68:71], v126, s[4:7], s59 offen sc1
  buffer_load_dwordx4 a[72:75], v126, s[4:7], s60 offen sc1
  buffer_load_dwordx4 a[76:79], v126, s[4:7], s61 offen sc1
  buffer_load_dwordx4 a[80:83], v126, s[4:7], s62 offen sc1
  buffer_load_dwordx4 a[84:87], v126, s[4:7], s63 offen sc1
  buffer_load_dwordx4 a[88:91], v126, s[4:7], s64 offen sc1
  buffer_load_dwordx4 a[92:95], v126, s[4:7], s65 offen sc1
  buffer_load_dwordx4 a[96:99], v126, s[4:7], s66 offen sc1
  buffer_load_dwordx4 a[100:103], v126, s[4:7], s67 offen sc1
  buffer_load_dwordx4 a[104:107], v126, s[4:7], s68 offen sc1
  buffer_load_dwordx4 a[108:111], v126, s[4:7], s69 offen sc1
  buffer_load_dwordx4 a[112:115], v126, s[4:7], s70 offen sc1
  buffer_load_dwordx4 a[116:119], v126, s[4:7], s71 offen sc1
  s_waitcnt vmcnt(0)
  v_mfma_f32_16x16x32_bf16 v[32:35], a[224:227], a[64:67], 0
  v_mfma_f32_16x16x32_bf16 v[32:35], a[240:243], a[68:71], v[32:35]
  v_mfma_f32_16x16x32_bf16 v[32:35], v[160:163], a[72:75], v[32:35]
  v_mfma_f32_16x16x32_bf16 v[32:35], v[176:179], a[76:79], v[32:35]
  v_mfma_f32_16x16x32_bf16 v[32:35], v[192:195], a[80:83], v[32:35]
  v_mfma_f32_16x16x32_bf16 v[32:35], v[208:211], a[84:87], v[32:35]
  v_mfma_f32_16x16x32_bf16 v[32:35], v[224:227], a[88:91], v[32:35]
  v_mfma_f32_16x16x32_bf16 v[32:35], v[240:243], a[92:95], v[32:35]
  v_mfma_f32_16x16x32_bf16 v[32:35], v[128:131], a[96:99], v[32:35]
  v_mfma_f32_16x16x32_bf16 v[32:35], v[144:147], a[100:103], v[32:35]
  v_mfma_f32_16x16x32_bf16 v[32:35], a[0:3], a[104:107], v[32:35]
  v_mfma_f32_16x16x32_bf16 v[32:35], a[16:19], a[108:111], v[32:35]
  v_mfma_f32_16x16x32_bf16 v[32:35], a[32:35], a[112:115], v[32:35]
  v_mfma_f32_16x16x32_bf16 v[32:35], a[48:51], a[116:119], v[32:35]
  s_nop 7
  s_nop 3
  v_cmp_u_f32 vcc, v32, v32
  s_nop 4
  s_cbranch_vccz L_rd_65
  s_sub_u32 s92, s92, 1
  s_cmp_lg_u32 s92, 0
  s_cbranch_scc1 L_rl_64
L_rd_65:
  v_mfma_f32_16x16x32_bf16 v[36:39], a[228:231], a[64:67], 0
  v_mfma_f32_16x16x32_bf16 v[40:43], a[232:235], a[64:67], 0
  v_mfma_f32_16x16x32_bf16 v[44:47], a[236:239], a[64:67], 0
  v_mfma_f32_16x16x32_bf16 v[36:39], a[244:247], a[68:71], v[36:39]
  v_mfma_f32_16x16x32_bf16 v[40:43], a[248:251], a[68:71], v[40:43]
  v_mfma_f32_16x16x32_bf16 v[44:47], a[252:255], a[68:71], v[44:47]
  v_mfma_f32_16x16x32_bf16 v[36:39], v[164:167], a[72:75], v[36:39]
  v_mfma_f32_16x16x32_bf16 v[40:43], v[168:171], a[72:75], v[40:43]
  v_mfma_f32_16x16x32_bf16 v[44:47], v[172:175], a[72:75], v[44:47]
  v_mfma_f32_16x16x32_bf16 v[36:39], v[180:183], a[76:79], v[36:39]
  v_mfma_f32_16x16x32_bf16 v[40:43], v[184:187], a[76:79], v[40:43]
  v_mfma_f32_16x16x32_bf16 v[44:47], v[188:191], a[76:79], v[44:47]
  v_mfma_f32_16x16x32_bf16 v[36:39], v[196:199], a[80:83], v[36:39]
  v_mfma_f32_16x16x32_bf16 v[40:43], v[200:203], a[80:83], v[40:43]
  v_mfma_f32_16x16x32_bf16 v[44:47], v[204:207], a[80:83], v[44:47]
  v_mfma_f32_16x16x32_bf16 v[36:39], v[212:215], a[84:87], v[36:39]
  v_mfma_f32_16x16x32_bf16 v[40:43], v[216:219], a[84:87], v[40:43]
  v_mfma_f32_16x16x32_bf16 v[44:47], v[220:223], a[84:87], v[44:47]
  v_mfma_f32_16x16x32_bf16 v[36:39], v[228:231], a[88:91], v[36:39]
  v_mfma_f32_16x16x32_bf16 v[40:43], v[232:235], a[88:91], v[40:43]
  v_mfma_f32_16x16x32_bf16 v[44:47], v[236:239], a[88:91], v[44:47]
  v_mfma_f32_16x16x32_bf16 v[36:39], v[244:247], a[92:95], v[36:39]
  v_mfma_f32_16x16x32_bf16 v[40:43], v[248:251], a[92:95], v[40:43]
  v_mfma_f32_16x16x32_bf16 v[44:47], v[252:255], a[92:95], v[44:47]
  v_mfma_f32_16x16x32_bf16 v[36:39], v[132:135], a[96:99], v[36:39]
  v_mfma_f32_16x16x32_bf16 v[40:43], v[136:139], a[96:99], v[40:43]
  v_mfma_f32_16x16x32_bf16 v[44:47], v[140:143], a[96:99], v[44:47]
  v_mfma_f32_16x16x32_bf16 v[36:39], v[148:151], a[100:103], v[36:39]
  v_mfma_f32_16x16x32_bf16 v[40:43], v[152:155], a[100:103], v[40:43]
  v_mfma_f32_16x16x32_bf16 v[44:47], v[156:159], a[100:103], v[44:47]
  v_mfma_f32_16x16x32_bf16 v[36:39], a[4:7], a[104:107], v[36:39]
  v_mfma_f32_16x16x32_bf16 v[40:43], a[8:11], a[104:107], v[40:43]
  v_mfma_f32_16x16x32_bf16 v[44:47], a[12:15], a[104:107], v[44:47]
  v_mfma_f32_16x16x32_bf16 v[36:39], a[20:23], a[108:111], v[36:39]
  v_mfma_f32_16x16x32_bf16 v[40:43], a[24:27], a[108:111], v[40:43]
  v_mfma_f32_16x16x32_bf16 v[44:47], a[28:31], a[108:111], v[44:47]
  v_mfma_f32_16x16x32_bf16 v[36:39], a[36:39], a[112:115], v[36:39]
  v_mfma_f32_16x16x32_bf16 v[40:43], a[40:43], a[112:115], v[40:43]
  v_mfma_f32_16x16x32_bf16 v[44:47], a[44:47], a[112:115], v[44:47]
  v_mfma_f32_16x16x32_bf16 v[36:39], a[52:55], a[116:119], v[36:39]
  v_mfma_f32_16x16x32_bf16 v[40:43], a[56:59], a[116:119], v[40:43]
  v_mfma_f32_16x16x32_bf16 v[44:47], a[60:63], a[116:119], v[44:47]
  s_nop 7
  s_nop 3
  s_branch L_back_41
L_redo_42:
  s_add_u32 s55, s50, 114688
  v_add_u32 v126, s55, v4
  s_mov_b32 s92, 40000
L_rl_66:
  buffer_load_dwordx4 a[120:123], v126, s[4:7], s58 offen sc1
  buffer_load_dwordx4 a[124:127], v126, s[4:7], s59 offen sc1
  buffer_load_dwordx4 a[128:131], v126, s[4:7], s60 offen sc1
  buffer_load_dwordx4 a[132:135], v126, s[4:7], s61 offen sc1
  buffer_load_dwordx4 a[136:139], v126, s[4:7], s62 offen sc1
  buffer_load_dwordx4 a[140:143], v126, s[4:7], s63 offen sc1
  buffer_load_dwordx4 a[144:147], v126, s[4:7], s64 offen sc1
  buffer_load_dwordx4 a[148:151], v126, s[4:7], s65 offen sc1
  buffer_load_dwordx4 a[152:155], v126, s[4:7], s66 offen sc1
  buffer_load_dwordx4 a[156:159], v126, s[4:7], s67 offen sc1
  buffer_load_dwordx4 a[160:163], v126, s[4:7], s68 offen sc1
  buffer_load_dwordx4 a[164:167], v126, s[4:7], s69 offen sc1
  buffer_load_dwordx4 a[168:171], v126, s[4:7], s70 offen sc1
  buffer_load_dwordx4 a[172:175], v126, s[4:7], s71 offen sc1
  s_waitcnt vmcnt(0)
  v_mfma_f32_16x16x32_bf16 v[48:51], a[224:227], a[120:123], 0
  v_mfma_f32_16x16x32_bf16 v[52:55], a[228:231], a[120:123], 0
  v_mfma_f32_16x16x32_bf16 v[48:51], a[240:243], a[124:127], v[48:51]
  v_mfma_f32_16x16x32_bf16 v[52:55], a[244:247], a[124:127], v[52:55]
  v_mfma_f32_16x16x32_bf16 v[48:51], v[160:163], a[128:131], v[48:51]
  v_mfma_f32_16x16x32_bf16 v[52:55], v[164:167], a[128:131], v[52:55]
  v_mfma_f32_16x16x32_bf16 v[48:51], v[176:179], a[132:135], v[48:51]
  v_mfma_f32_16x16x32_bf16 v[52:55], v[180:183], a[132:135], v[52:55]
  v_mfma_f32_16x16x32_bf16 v[48:51], v[192:195], a[136:139], v[48:51]
  v_mfma_f32_16x16x32_bf16 v[52:55], v[196:199], a[136:139], v[52:55]
  v_mfma_f32_16x16x32_bf16 v[48:51], v[208:211], a[140:143], v[48:51]
  v_mfma_f32_16x16x32_bf16 v[52:55], v[212:215], a[140:143], v[52:55]
  v_mfma_f32_16x16x32_bf16 v[48:51], v[224:227], a[144:147], v[48:51]
  v_mfma_f32_16x16x32_bf16 v[52:55], v[228:231], a[144:147], v[52:55]
  v_mfma_f32_16x16x32_bf16 v[48:51], v[240:243], a[148:151], v[48:51]
  v_mfma_f32_16x16x32_bf16 v[52:55], v[244:247], a[148:151], v[52:55]
  v_mfma_f32_16x16x32_bf16 v[48:51], v[128:131], a[152:155], v[48:51]
  v_mfma_f32_16x16x32_bf16 v[52:55], v[132:135], a[152:155], v[52:55]
  v_mfma_f32_16x16x32_bf16 v[48:51], v[144:147], a[156:159], v[48:51]
  v_mfma_f32_16x16x32_bf16 v[52:55], v[148:151], a[156:159], v[52:55]
  v_mfma_f32_16x16x32_bf16 v[48:51], a[0:3], a[160:163], v[48:51]
  v_mfma_f32_16x16x32_bf16 v[52:55], a[4:7], a[160:163], v[52:55]
  v_mfma_f32_16x16x32_bf16 v[48:51], a[16:19], a[164:167], v[48:51]
  v_mfma_f32_16x16x32_bf16 v[52:55], a[20:23], a[164:167], v[52:55]
  v_mfma_f32_16x16x32_bf16 v[48:51], a[32:35], a[168:171], v[48:51]
  v_mfma_f32_16x16x32_bf16 v[52:55], a[36:39], a[168:171], v[52:55]
  v_mfma_f32_16x16x32_bf16 v[48:51], a[48:51], a[172:175], v[48:51]
  v_mfma_f32_16x16x32_bf16 v[52:55], a[52:55], a[172:175], v[52:55]
  s_nop 7
  s_nop 3
  v_cmp_u_f32 vcc, v48, v48
  s_nop 4
  s_cbranch_vccz L_rd_67
  s_sub_u32 s92, s92, 1
  s_cmp_lg_u32 s92, 0
  s_cbranch_scc1 L_rl_66
L_rd_67:
  v_mfma_f32_16x16x32_bf16 v[56:59], a[232:235], a[120:123], 0
  v_mfma_f32_16x16x32_bf16 v[60:63], a[236:239], a[120:123], 0
  v_mfma_f32_16x16x32_bf16 v[56:59], a[248:251], a[124:127], v[56:59]
  v_mfma_f32_16x16x32_bf16 v[60:63], a[252:255], a[124:127], v[60:63]
  v_mfma_f32_16x16x32_bf16 v[56:59], v[168:171], a[128:131], v[56:59]
  v_mfma_f32_16x16x32_bf16 v[60:63], v[172:175], a[128:131], v[60:63]
  s_branch L_back_43
L_redo_44:
  s_add_u32 s55, s50, 229376
  v_add_u32 v126, s55, v4
  s_mov_b32 s92, 40000
L_rl_68:
  buffer_load_dwordx4 a[64:67], v126, s[4:7], s58 offen sc1
  buffer_load_dwordx4 a[68:71], v126, s[4:7], s59 offen sc1
  buffer_load_dwordx4 a[72:75], v126, s[4:7], s60 offen sc1
  buffer_load_dwordx4 a[76:79], v126, s[4:7], s61 offen sc1
  buffer_load_dwordx4 a[80:83], v126, s[4:7], s62 offen sc1
  buffer_load_dwordx4 a[84:87], v126, s[4:7], s63 offen sc1
  buffer_load_dwordx4 a[88:91], v126, s[4:7], s64 offen sc1
  buffer_load_dwordx4 a[92:95], v126, s[4:7], s65 offen sc1
  buffer_load_dwordx4 a[96:99], v126, s[4:7], s66 offen sc1
  buffer_load_dwordx4 a[100:103], v126, s[4:7], s67 offen sc1
  buffer_load_dwordx4 a[104:107], v126, s[4:7], s68 offen sc1
  buffer_load_dwordx4 a[108:111], v126, s[4:7], s69 offen sc1
  buffer_load_dwordx4 a[112:115], v126, s[4:7], s70 offen sc1
  buffer_load_dwordx4 a[116:119], v126, s[4:7], s71 offen sc1
  s_waitcnt vmcnt(0)
  v_mfma_f32_16x16x32_bf16 v[32:35], a[224:227], a[64:67], 0
  v_mfma_f32_16x16x32_bf16 v[36:39], a[228:231], a[64:67], 0
  v_mfma_f32_16x16x32_bf16 v[32:35], a[240:243], a[68:71], v[32:35]
  v_mfma_f32_16x16x32_bf16 v[36:39], a[244:247], a[68:71], v[36:39]
  v_mfma_f32_16x16x32_bf16 v[32:35], v[160:163], a[72:75], v[32:35]
  v_mfma_f32_16x16x32_bf16 v[36:39], v[164:167], a[72:75], v[36:39]
  v_mfma_f32_16x16x32_bf16 v[32:35], v[176:179], a[76:79], v[32:35]
  v_mfma_f32_16x16x32_bf16 v[36:39], v[180:183], a[76:79], v[36:39]
  v_mfma_f32_16x16x32_bf16 v[32:35], v[192:195], a[80:83], v[32:35]
  v_mfma_f32_16x16x32_bf16 v[36:39], v[196:199], a[80:83], v[36:39]
  v_mfma_f32_16x16x32_bf16 v[32:35], v[208:211], a[84:87], v[32:35]
  v_mfma_f32_16x16x32_bf16 v[36:39], v[212:215], a[84:87], v[36:39]
  v_mfma_f32_16x16x32_bf16 v[32:35], v[224:227], a[88:91], v[32:35]
  v_mfma_f32_16x16x32_bf16 v[36:39], v[228:231], a[88:91], v[36:39]
  v_mfma_f32_16x16x32_bf16 v[32:35], v[240:243], a[92:95], v[32:35]
  v_mfma_f32_16x16x32_bf16 v[36:39], v[244:247], a[92:95], v[36:39]
  v_mfma_f32_16x16x32_bf16 v[32:35], v[128:131], a[96:99], v[32:35]
  v_mfma_f32_16x16x32_bf16 v[36:39], v[132:135], a[96:99], v[36:39]
  v_mfma_f32_16x16x32_bf16 v[32:35], v[144:147], a[100:103], v[32:35]
  v_mfma_f32_16x16x32_bf16 v[36:39], v[148:151], a[100:103], v[36:39]
  v_mfma_f32_16x16x32_bf16 v[32:35], a[0:3], a[104:107], v[32:35]
  v_mfma_f32_16x16x32_bf16 v[36:39], a[4:7], a[104:107], v[36:39]
  v_mfma_f32_16x16x32_bf16 v[32:35], a[16:19], a[108:111], v[32:35]
  v_mfma_f32_16x16x32_bf16 v[36:39], a[20:23], a[108:111], v[36:39]
  v_mfma_f32_16x16x32_bf16 v[32:35], a[32:35], a[112:115], v[32:35]
  v_mfma_f32_16x16x32_bf16 v[36:39], a[36:39], a[112:115], v[36:39]
  v_mfma_f32_16x16x32_bf16 v[32:35], a[48:51], a[116:119], v[32:35]
  v_mfma_f32_16x16x32_bf16 v[36:39], a[52:55], a[116:119], v[36:39]
  s_nop 7
  s_nop 3
  v_cmp_u_f32 vcc, v32, v32
  s_nop 4
  s_cbranch_vccz L_rd_69
  s_sub_u32 s92, s92, 1
  s_cmp_lg_u32 s92, 0
  s_cbranch_scc1 L_rl_68
L_rd_69:
  v_mfma_f32_16x16x32_bf16 v[40:43], a[232:235], a[64:67], 0
  v_mfma_f32_16x16x32_bf16 v[44:47], a[236:239], a[64:67], 0
  v_mfma_f32_16x16x32_bf16 v[40:43], a[248:251], a[68:71], v[40:43]
  v_mfma_f32_16x16x32_bf16 v[44:47], a[252:255], a[68:71], v[44:47]
  v_mfma_f32_16x16x32_bf16 v[40:43], v[168:171], a[72:75], v[40:43]
  v_mfma_f32_16x16x32_bf16 v[44:47], v[172:175], a[72:75], v[44:47]
  s_branch L_back_45
L_redo_46:
  s_add_u32 s55, s50, 344064
  v_add_u32 v126, s55, v4
  s_mov_b32 s92, 40000
L_rl_70:
  buffer_load_dwordx4 a[120:123], v126, s[4:7], s58 offen sc1
  buffer_load_dwordx4 a[124:127], v126, s[4:7], s59 offen sc1
  buffer_load_dwordx4 a[128:131], v126, s[4:7], s60 offen sc1
  buffer_load_dwordx4 a[132:135], v126, s[4:7], s61 offen sc1
  buffer_load_dwordx4 a[136:139], v126, s[4:7], s62 offen sc1
  buffer_load_dwordx4 a[140:143], v126, s[4:7], s63 offen sc1
  buffer_load_dwordx4 a[144:147], v126, s[4:7], s64 offen sc1
  buffer_load_dwordx4 a[148:151], v126, s[4:7], s65 offen sc1
  buffer_load_dwordx4 a[152:155], v126, s[4:7], s66 offen sc1
  buffer_load_dwordx4 a[156:159], v126, s[4:7], s67 offen sc1
  buffer_load_dwordx4 a[160:163], v126, s[4:7], s68 offen sc1
  buffer_load_dwordx4 a[164:167], v126, s[4:7], s69 offen sc1
  buffer_load_dwordx4 a[168:171], v126, s[4:7], s70 offen sc1
  buffer_load_dwordx4 a[172:175], v126, s[4:7], s71 offen sc1
  s_waitcnt vmcnt(0)
  v_mfma_f32_16x16x32_bf16 v[48:51], a[224:227], a[120:123], 0
  v_mfma_f32_16x16x32_bf16 v[52:55], a[228:231], a[120:123], 0
  v_mfma_f32_16x16x32_bf16 v[48:51], a[240:243], a[124:127], v[48:51]
  v_mfma_f32_16x16x32_bf16 v[52:55], a[244:247], a[124:127], v[52:55]
  v_mfma_f32_16x16x32_bf16 v[48:51], v[160:163], a[128:131], v[48:51]
  v_mfma_f32_16x16x32_bf16 v[52:55], v[164:167], a[128:131], v[52:55]
  v_mfma_f32_16x16x32_bf16 v[48:51], v[176:179], a[132:135], v[48:51]
  v_mfma_f32_16x16x32_bf16 v[52:55], v[180:183], a[132:135], v[52:55]
  v_mfma_f32_16x16x32_bf16 v[48:51], v[192:195], a[136:139], v[48:51]
  v_mfma_f32_16x16x32_bf16 v[52:55], v[196:199], a[136:139], v[52:55]
  v_mfma_f32_16x16x32_bf16 v[48:51], v[208:211], a[140:143], v[48:51]
  v_mfma_f32_16x16x32_bf16 v[52:55], v[212:215], a[140:143], v[52:55]
  v_mfma_f32_16x16x32_bf16 v[48:51], v[224:227], a[144:147], v[48:51]
  v_mfma_f32_16x16x32_bf16 v[52:55], v[228:231], a[144:147], v[52:55]
  v_mfma_f32_16x16x32_bf16 v[48:51], v[240:243], a[148:151], v[48:51]
  v_mfma_f32_16x16x32_bf16 v[52:55], v[244:247], a[148:151], v[52:55]
  v_mfma_f32_16x16x32_bf16 v[48:51], v[128:131], a[152:155], v[48:51]
  v_mfma_f32_16x16x32_bf16 v[52:55], v[132:135], a[152:155], v[52:55]
  v_mfma_f32_16x16x32_bf16 v[48:51], v[144:147], a[156:159], v[48:51]
  v_mfma_f32_16x16x32_bf16 v[52:55], v[148:151], a[156:159], v[52:55]
  v_mfma_f32_16x16x32_bf16 v[48:51], a[0:3], a[160:163], v[48:51]
  v_mfma_f32_16x16x32_bf16 v[52:55], a[4:7], a[160:163], v[52:55]
  v_mfma_f32_16x16x32_bf16 v[48:51], a[16:19], a[164:167], v[48:51]
  v_mfma_f32_16x16x32_bf16 v[52:55], a[20:23], a[164:167], v[52:55]
  v_mfma_f32_16x16x32_bf16 v[48:51], a[32:35], a[168:171], v[48:51]
  v_mfma_f32_16x16x32_bf16 v[52:55], a[36:39], a[168:171], v[52:55]
  v_mfma_f32_16x16x32_bf16 v[48:51], a[48:51], a[172:175], v[48:51]
  v_mfma_f32_16x16x32_bf16 v[52:55], a[52:55], a[172:175], v[52:55]
  s_nop 7
  s_nop 3
  v_cmp_u_f32 vcc, v48, v48
  s_nop 4
  s_cbranch_vccz L_rd_71
  s_sub_u32 s92, s92, 1
  s_cmp_lg_u32 s92, 0
  s_cbranch_scc1 L_rl_70
L_rd_71:
  v_mfma_f32_16x16x32_bf16 v[56:59], a[232:235], a[120:123], 0
  v_mfma_f32_16x16x32_bf16 v[60:63], a[236:239], a[120:123], 0
  v_mfma_f32_16x16x32_bf16 v[56:59], a[248:251], a[124:127], v[56:59]
  v_mfma_f32_16x16x32_bf16 v[60:63], a[252:255], a[124:127], v[60:63]
  v_mfma_f32_16x16x32_bf16 v[56:59], v[168:171], a[128:131], v[56:59]
  v_mfma_f32_16x16x32_bf16 v[60:63], v[172:175], a[128:131], v[60:63]
  s_branch L_back_47
L_mk_20:
  s_mov_b32 s73, m0
  s_mov_b32 s92, 40000
L_mkl_72:
  s_add_u32 s56, s72, 0
  s_mul_i32 s56, s56, 28672
  s_mul_i32 s57, s3, 7168
  s_add_u32 s56, s56, s57
  s_add_u32 s56, s56, 4194304
  s_add_u32 m0, s57, 0
  s_nop 0
  buffer_load_dwordx4 v4, s[4:7], s56 offen offset:0 sc1 lds
  buffer_load_dwordx4 v4, s[4:7], s56 offen offset:1024 sc1 lds
  buffer_load_dwordx4 v4, s[4:7], s56 offen offset:2048 sc1 lds
  buffer_load_dwordx4 v4, s[4:7], s56 offen offset:3072 sc1 lds
  s_add_u32 s56, s56, 4096
  s_add_u32 m0, s57, 4096
  s_nop 0
  buffer_load_dwordx4 v4, s[4:7], s56 offen offset:0 sc1 lds
  buffer_load_dwordx4 v4, s[4:7], s56 offen offset:1024 sc1 lds
  buffer_load_dwordx4 v4, s[4:7], s56 offen offset:2048 sc1 lds
  s_waitcnt vmcnt(0)
  ds_read_b128 v[128:131], v122 offset:0
  ds_read_b128 v[132:135], v122 offset:1024
  ds_read_b128 v[136:139], v122 offset:2048
  ds_read_b128 v[140:143], v122 offset:3072
  ds_read_b128 v[144:147], v122 offset:4096
  ds_read_b128 v[148:151], v122 offset:5120
  ds_read_b128 v[152:155], v122 offset:6144
  s_waitcnt lgkmcnt(0)
  v_max3_u32 v128, v128, v129, v130
  v_max3_u32 v128, v128, v131, v132
  v_max3_u32 v128, v128, v133, v134
  v_max3_u32 v128, v128, v135, v136
  v_max3_u32 v128, v128, v137, v138
  v_max3_u32 v128, v128, v139, v140
  v_max3_u32 v128, v128, v141, v142
  v_max3_u32 v128, v128, v143, v144
  v_max3_u32 v128, v128, v145, v146
  v_max3_u32 v128, v128, v147, v148
  v_max3_u32 v128, v128, v149, v150
  v_max3_u32 v128, v128, v151, v152
  v_max3_u32 v128, v128, v153, v154
  v_max_u32 v128, v128, v155
  v_cmp_eq_u32 vcc, -1, v128
  s_nop 4
  s_cbranch_vccz L_mkd_73
  s_sub_u32 s92, s92, 1
  s_cmp_lg_u32 s92, 0
  s_cbranch_scc1 L_mkl_72
L_mkd_73:
  s_mov_b32 m0, s73
  s_branch L_mkb_21
L_mk_22:
  s_mov_b32 s73, m0
  s_mov_b32 s92, 40000
L_mkl_74:
  s_add_u32 s56, s72, 1
  s_mul_i32 s56, s56, 28672
  s_mul_i32 s57, s3, 7168
  s_add_u32 s56, s56, s57
  s_add_u32 s56, s56, 4194304
  s_add_u32 m0, s57, 28672
  s_nop 0
  buffer_load_dwordx4 v4, s[4:7], s56 offen offset:0 sc1 lds
  buffer_load_dwordx4 v4, s[4:7], s56 offen offset:1024 sc1 lds
  buffer_load_dwordx4 v4, s[4:7], s56 offen offset:2048 sc1 lds
  buffer_load_dwordx4 v4, s[4:7], s56 offen offset:3072 sc1 lds
  s_add_u32 s56, s56, 4096
  s_add_u32 m0, s57, 32768
  s_nop 0
  buffer_load_dwordx4 v4, s[4:7], s56 offen offset:0 sc1 lds
  buffer_load_dwordx4 v4, s[4:7], s56 offen offset:1024 sc1 lds
  buffer_load_dwordx4 v4, s[4:7], s56 offen offset:2048 sc1 lds
  s_waitcnt vmcnt(0)
  ds_read_b128 v[128:131], v122 offset:28672
  ds_read_b128 v[132:135], v122 offset:29696
  ds_read_b128 v[136:139], v122 offset:30720
  ds_read_b128 v[140:143], v122 offset:31744
  ds_read_b128 v[144:147], v122 offset:32768
  ds_read_b128 v[148:151], v122 offset:33792
  ds_read_b128 v[152:155], v122 offset:34816
  s_waitcnt lgkmcnt(0)
  v_max3_u32 v128, v128, v129, v130
  v_max3_u32 v128, v128, v131, v132
  v_max3_u32 v128, v128, v133, v134
  v_max3_u32 v128, v128, v135, v136
  v_max3_u32 v128, v128, v137, v138
  v_max3_u32 v128, v128, v139, v140
  v_max3_u32 v128, v128, v141, v142
  v_max3_u32 v128, v128, v143, v144
  v_max3_u32 v128, v128, v145, v146
  v_max3_u32 v128, v128, v147, v148
  v_max3_u32 v128, v128, v149, v150
  v_max3_u32 v128, v128, v151, v152
  v_max3_u32 v128, v128, v153, v154
  v_max_u32 v128, v128, v155
  v_cmp_eq_u32 vcc, -1, v128
  s_nop 4
  s_cbranch_vccz L_mkd_75
  s_sub_u32 s92, s92, 1
  s_cmp_lg_u32 s92, 0
  s_cbranch_scc1 L_mkl_74
L_mkd_75:
  s_mov_b32 m0, s73
  s_branch L_mkb_23
L_fh_26:
  s_mov_b32 s92, 40000
L_fhl_76:
  buffer_load_dword v125, v126, s[4:7], 0 offen sc1
  s_waitcnt vmcnt(0)
  v_cmp_gt_u32 vcc, 32, v125
  s_nop 4
  s_cbranch_vccz L_fhb_27
  s_sub_u32 s92, s92, 1
  s_cmp_lg_u32 s92, 0
  s_cbranch_scc1 L_fhl_76
  s_branch L_fhb_27
L_mk_28:
  s_mov_b32 s73, m0
  s_mov_b32 s92, 40000
L_mkl_77:
  s_add_u32 s56, s72, 2
  s_mul_i32 s56, s56, 28672
  s_mul_i32 s57, s3, 7168
  s_add_u32 s56, s56, s57
  s_add_u32 s56, s56, 4194304
  s_add_u32 m0, s57, 57344
  s_nop 0
  buffer_load_dwordx4 v4, s[4:7], s56 offen offset:0 sc1 lds
  buffer_load_dwordx4 v4, s[4:7], s56 offen offset:1024 sc1 lds
  buffer_load_dwordx4 v4, s[4:7], s56 offen offset:2048 sc1 lds
  buffer_load_dwordx4 v4, s[4:7], s56 offen offset:3072 sc1 lds
  s_add_u32 s56, s56, 4096
  s_add_u32 m0, s57, 61440
  s_nop 0
  buffer_load_dwordx4 v4, s[4:7], s56 offen offset:0 sc1 lds
  buffer_load_dwordx4 v4, s[4:7], s56 offen offset:1024 sc1 lds
  buffer_load_dwordx4 v4, s[4:7], s56 offen offset:2048 sc1 lds
  s_waitcnt vmcnt(0)
  ds_read_b128 v[128:131], v122 offset:57344
  ds_read_b128 v[132:135], v122 offset:58368
  ds_read_b128 v[136:139], v122 offset:59392
  ds_read_b128 v[140:143], v122 offset:60416
  ds_read_b128 v[144:147], v122 offset:61440
  ds_read_b128 v[148:151], v122 offset:62464
  ds_read_b128 v[152:155], v122 offset:63488
  s_waitcnt lgkmcnt(0)
  v_max3_u32 v128, v128, v129, v130
  v_max3_u32 v128, v128, v131, v132
  v_max3_u32 v128, v128, v133, v134
  v_max3_u32 v128, v128, v135, v136
  v_max3_u32 v128, v128, v137, v138
  v_max3_u32 v128, v128, v139, v140
  v_max3_u32 v128, v128, v141, v142
  v_max3_u32 v128, v128, v143, v144
  v_max3_u32 v128, v128, v145, v146
  v_max3_u32 v128, v128, v147, v148
  v_max3_u32 v128, v128, v149, v150
  v_max3_u32 v128, v128, v151, v152
  v_max3_u32 v128, v128, v153, v154
  v_max_u32 v128, v128, v155
  v_cmp_eq_u32 vcc, -1, v128
  s_nop 4
  s_cbranch_vccz L_mkd_78
  s_sub_u32 s92, s92, 1
  s_cmp_lg_u32 s92, 0
  s_cbranch_scc1 L_mkl_77
L_mkd_78:
  s_mov_b32 m0, s73
  s_branch L_mkb_29
L_mk_32:
  s_mov_b32 s73, m0
  s_mov_b32 s92, 40000
L_mkl_79:
  s_add_u32 s56, s72, 3
  s_mul_i32 s56, s56, 28672
  s_mul_i32 s57, s3, 7168
  s_add_u32 s56, s56, s57
  s_add_u32 s56, s56, 4194304
  s_add_u32 m0, s57, 0
  s_nop 0
  buffer_load_dwordx4 v4, s[4:7], s56 offen offset:0 sc1 lds
  buffer_load_dwordx4 v4, s[4:7], s56 offen offset:1024 sc1 lds
  buffer_load_dwordx4 v4, s[4:7], s56 offen offset:2048 sc1 lds
  buffer_load_dwordx4 v4, s[4:7], s56 offen offset:3072 sc1 lds
  s_add_u32 s56, s56, 4096
  s_add_u32 m0, s57, 4096
  s_nop 0
  buffer_load_dwordx4 v4, s[4:7], s56 offen offset:0 sc1 lds
  buffer_load_dwordx4 v4, s[4:7], s56 offen offset:1024 sc1 lds
  buffer_load_dwordx4 v4, s[4:7], s56 offen offset:2048 sc1 lds
  s_waitcnt vmcnt(0)
  ds_read_b128 v[128:131], v122 offset:0
  ds_read_b128 v[132:135], v122 offset:1024
  ds_read_b128 v[136:139], v122 offset:2048
  ds_read_b128 v[140:143], v122 offset:3072
  ds_read_b128 v[144:147], v122 offset:4096
  ds_read_b128 v[148:151], v122 offset:5120
  ds_read_b128 v[152:155], v122 offset:6144
  s_waitcnt lgkmcnt(0)
  v_max3_u32 v128, v128, v129, v130
  v_max3_u32 v128, v128, v131, v132
  v_max3_u32 v128, v128, v133, v134
  v_max3_u32 v128, v128, v135, v136
  v_max3_u32 v128, v128, v137, v138
  v_max3_u32 v128, v128, v139, v140
  v_max3_u32 v128, v128, v141, v142
  v_max3_u32 v128, v128, v143, v144
  v_max3_u32 v128, v128, v145, v146
  v_max3_u32 v128, v128, v147, v148
  v_max3_u32 v128, v128, v149, v150
  v_max3_u32 v128, v128, v151, v152
  v_max3_u32 v128, v128, v153, v154
  v_max_u32 v128, v128, v155
  v_cmp_eq_u32 vcc, -1, v128
  s_nop 4
  s_cbranch_vccz L_mkd_80
  s_sub_u32 s92, s92, 1
  s_cmp_lg_u32 s92, 0
  s_cbranch_scc1 L_mkl_79
L_mkd_80:
  s_mov_b32 m0, s73
  s_branch L_mkb_33
L_mk_36:
  s_mov_b32 s73, m0
  s_mov_b32 s92, 40000
L_mkl_81:
  v_lshrrev_b32 v126, 1, v1
  v_lshlrev_b32 v126, 6, v126
  v_and_b32 v29, 1, v1
  v_lshl_add_u32 v126, v29, 4, v126
  s_lshl_b32 s56, s89, 2
  s_add_u32 s56, s56, s3
  s_mul_i32 s56, s56, 28672
  s_lshl_b32 s57, s91, 12
  s_add_u32 s56, s56, s57
  s_lshl_b32 s57, s90, 5
  s_add_u32 s56, s56, s57
  s_add_u32 s56, s56, 4194304
  s_lshl_b32 s57, s3, 11
  s_add_u32 m0, s57, 151552
  s_nop 0
  buffer_load_dwordx4 v126, s[4:7], s56 offen sc1 lds
  s_add_u32 s56, s56, 2048
  s_add_u32 m0, s57, 152576
  s_nop 0
  buffer_load_dwordx4 v126, s[4:7], s56 offen sc1 lds
  s_waitcnt vmcnt(0)
  ds_read_b128 v[116:119], v125 offset:0
  ds_read_b128 v[120:123], v125 offset:1024
  s_waitcnt lgkmcnt(0)
  v_max3_u32 v116, v116, v117, v118
  v_max3_u32 v116, v116, v119, v120
  v_max3_u32 v116, v116, v121, v122
  v_max_u32 v116, v116, v123
  v_cmp_eq_u32 vcc, -1, v116
  s_nop 4
  s_cbranch_vccz L_mkd_82
  s_sub_u32 s92, s92, 1
  s_cmp_lg_u32 s92, 0
  s_cbranch_scc1 L_mkl_81
L_mkd_82:
  s_mov_b32 m0, s73
  s_branch L_mkb_37
L_mk_57:
  s_mov_b32 s73, m0
  s_mov_b32 s92, 40000
L_mkl_83:
  s_add_u32 s56, s51, 0
  s_mul_i32 s56, s56, 28672
  s_mul_i32 s57, s3, 7168
  s_add_u32 s56, s56, s57
  s_add_u32 s56, s56, 4194304
  s_add_u32 m0, s57, 0
  s_nop 0
  buffer_load_dwordx4 v9, s[4:7], s56 offen offset:0 sc1 lds
  buffer_load_dwordx4 v9, s[4:7], s56 offen offset:1024 sc1 lds
  buffer_load_dwordx4 v9, s[4:7], s56 offen offset:2048 sc1 lds
  buffer_load_dwordx4 v9, s[4:7], s56 offen offset:3072 sc1 lds
  s_add_u32 s56, s56, 4096
  s_add_u32 m0, s57, 4096
  s_nop 0
  buffer_load_dwordx4 v9, s[4:7], s56 offen offset:0 sc1 lds
  buffer_load_dwordx4 v9, s[4:7], s56 offen offset:1024 sc1 lds
  buffer_load_dwordx4 v9, s[4:7], s56 offen offset:2048 sc1 lds
  s_waitcnt vmcnt(0)
  ds_read_b128 v[64:67], v92 offset:0
  ds_read_b128 v[68:71], v92 offset:1024
  ds_read_b128 v[72:75], v92 offset:2048
  ds_read_b128 v[76:79], v92 offset:3072
  ds_read_b128 v[80:83], v92 offset:4096
  ds_read_b128 v[84:87], v92 offset:5120
  ds_read_b128 v[88:91], v92 offset:6144
  s_waitcnt lgkmcnt(0)
  v_max3_u32 v64, v64, v65, v66
  v_max3_u32 v64, v64, v67, v68
  v_max3_u32 v64, v64, v69, v70
  v_max3_u32 v64, v64, v71, v72
  v_max3_u32 v64, v64, v73, v74
  v_max3_u32 v64, v64, v75, v76
  v_max3_u32 v64, v64, v77, v78
  v_max3_u32 v64, v64, v79, v80
  v_max3_u32 v64, v64, v81, v82
  v_max3_u32 v64, v64, v83, v84
  v_max3_u32 v64, v64, v85, v86
  v_max3_u32 v64, v64, v87, v88
  v_max3_u32 v64, v64, v89, v90
  v_max_u32 v64, v64, v91
  v_cmp_eq_u32 vcc, -1, v64
  s_nop 4
  s_cbranch_vccz L_mkd_84
  s_sub_u32 s92, s92, 1
  s_cmp_lg_u32 s92, 0
  s_cbranch_scc1 L_mkl_83
L_mkd_84:
  s_mov_b32 m0, s73
  s_branch L_mkb_58
L_mk_60:
  s_mov_b32 s73, m0
  s_mov_b32 s92, 40000
L_mkl_85:
  s_add_u32 s56, s51, 2
  s_mul_i32 s56, s56, 28672
  s_mul_i32 s57, s3, 7168
  s_add_u32 s56, s56, s57
  s_add_u32 s56, s56, 4194304
  s_add_u32 m0, s57, 28672
  s_nop 0
  buffer_load_dwordx4 v9, s[4:7], s56 offen offset:0 sc1 lds
  buffer_load_dwordx4 v9, s[4:7], s56 offen offset:1024 sc1 lds
  buffer_load_dwordx4 v9, s[4:7], s56 offen offset:2048 sc1 lds
  buffer_load_dwordx4 v9, s[4:7], s56 offen offset:3072 sc1 lds
  s_add_u32 s56, s56, 4096
  s_add_u32 m0, s57, 32768
  s_nop 0
  buffer_load_dwordx4 v9, s[4:7], s56 offen offset:0 sc1 lds
  buffer_load_dwordx4 v9, s[4:7], s56 offen offset:1024 sc1 lds
  buffer_load_dwordx4 v9, s[4:7], s56 offen offset:2048 sc1 lds
  s_waitcnt vmcnt(0)
  ds_read_b128 v[64:67], v92 offset:28672
  ds_read_b128 v[68:71], v92 offset:29696
  ds_read_b128 v[72:75], v92 offset:30720
  ds_read_b128 v[76:79], v92 offset:31744
  ds_read_b128 v[80:83], v92 offset:32768
  ds_read_b128 v[84:87], v92 offset:33792
  ds_read_b128 v[88:91], v92 offset:34816
  s_waitcnt lgkmcnt(0)
  v_max3_u32 v64, v64, v65, v66
  v_max3_u32 v64, v64, v67, v68
  v_max3_u32 v64, v64, v69, v70
  v_max3_u32 v64, v64, v71, v72
  v_max3_u32 v64, v64, v73, v74
  v_max3_u32 v64, v64, v75, v76
  v_max3_u32 v64, v64, v77, v78
  v_max3_u32 v64, v64, v79, v80
  v_max3_u32 v64, v64, v81, v82
  v_max3_u32 v64, v64, v83, v84
  v_max3_u32 v64, v64, v85, v86
  v_max3_u32 v64, v64, v87, v88
  v_max3_u32 v64, v64, v89, v90
  v_max_u32 v64, v64, v91
  v_cmp_eq_u32 vcc, -1, v64
  s_nop 4
  s_cbranch_vccz L_mkd_86
  s_sub_u32 s92, s92, 1
  s_cmp_lg_u32 s92, 0
  s_cbranch_scc1 L_mkl_85
L_mkd_86:
  s_mov_b32 m0, s73
  s_branch L_mkb_61
L_exit:
  s_waitcnt vmcnt(0) lgkmcnt(0)
L_end:
  s_endpgm
L_codeend:

.section .rodata,"a"
.p2align 6
.amdhsa_kernel sequential_preLN__ssm_conv_h3__glu_gated_glu__prompt_kernel
  .amdhsa_next_free_vgpr 512
  .amdhsa_next_free_sgpr 102
  .amdhsa_accum_offset 256
  .amdhsa_group_segment_fixed_size 0
  .amdhsa_kernarg_size 104
  .amdhsa_user_sgpr_count 2
  .amdhsa_user_sgpr_kernarg_segment_ptr 1
  .amdhsa_system_sgpr_workgroup_id_x 1
.end_amdhsa_kernel
```
